```python
import torch

def _softmax(x, axis=-1):
    return torch.softmax(x, dim=axis)
def _gelu(x):
    return torch.nn.functional.gelu(x, approximate="tanh")
def _silu(x):
    return torch.nn.functional.silu(x)
def _sigmoid(x):
    return torch.sigmoid(x)
def _layernorm(x, axis=-1, eps=1e-5):
    m = x.mean(dim=axis, keepdim=True)
    v = x.var(dim=axis, keepdim=True, unbiased=False)
    return (x - m) / torch.sqrt(v + eps)
def _scatter_add(tgt, idx, src, axis=0):
    return tgt.clone().index_add_(axis, idx, src)
def _segment_sum(src, seg, n):
    out = torch.zeros((n,) + src.shape[1:], dtype=src.dtype)
    return out.index_add_(0, seg, src)
def _pad(x, pw):
    flat = tuple(v for pair in reversed(pw) for v in pair)
    return torch.nn.functional.pad(x, flat)

kernel_name = 'interleave_layers__ssm_conv_s4d__spectral_gfnet__prompt'

def setup_inputs():

    _w = (lambda a: (lambda t: t.to(torch.bfloat16) if t.is_floating_point() else t)(torch.as_tensor(a)))
    def _A_setup():
        Bsz, L, D, N = 1, 2048, 512, 128
        return {
            "u": _w((lambda *s: torch.randn(*s, dtype=torch.bfloat16) * 0.05)(Bsz, L, D)),
            "log_A_real": _w((lambda *s: torch.randn(*s, dtype=torch.bfloat16) * 3.2)(D, N) * 0.5),
            "A_imag": _w((lambda *s: torch.randn(*s, dtype=torch.bfloat16) * 0.05)(D, N) * 3.14),
            "C_real": _w((lambda *s: torch.randn(*s, dtype=torch.bfloat16) * 0.05)(D, N) / N ** 0.5),
            "C_imag": _w((lambda *s: torch.randn(*s, dtype=torch.bfloat16) * 0.05)(D, N) / N ** 0.5),
            "log_dt": _w((lambda *s: torch.randn(*s, dtype=torch.bfloat16) * 0.05)(D) * 0.5 - 4.0),
            "D_skip": _w((lambda *s: torch.randn(*s, dtype=torch.bfloat16) * 0.05)(D)),
        }
    _A_in = _A_setup()

    def _B_setup():
        B, S, D = 1, 2048, 512
        Df = D // 2 + 1
        return {
            "x": _w((lambda *s: torch.randn(*s, dtype=torch.bfloat16) * 0.05)(B, S, D)),
            "w_r": _w((lambda *s: torch.randn(*s, dtype=torch.bfloat16) * 3.2)(S, Df) * 0.02),
            "w_i": _w((lambda *s: torch.randn(*s, dtype=torch.bfloat16) * 3.2)(S, Df) * 0.02),
        }
    _B_in = _B_setup()

    return {
        "A_u": _A_in["u"],
        "A_log_A_real": _A_in["log_A_real"],
        "A_A_imag": _A_in["A_imag"],
        "A_C_real": _A_in["C_real"],
        "A_C_imag": _A_in["C_imag"],
        "A_log_dt": _A_in["log_dt"],
        "A_D_skip": _A_in["D_skip"],
        "B_x": _B_in["x"],
        "B_w_r": _B_in["w_r"],
        "B_w_i": _B_in["w_i"],
    }

def reference(A_u, A_log_A_real, A_A_imag, A_C_real, A_C_imag, A_log_dt, A_D_skip, B_x, B_w_r, B_w_i):
    def _A_ref(u, log_A_real, A_imag, C_real, C_imag, log_dt, D_skip):
        L = u.shape[1]
        dt = torch.exp(log_dt)
        A = -torch.exp(log_A_real) + 1j * A_imag
        C = (C_real + 1j * C_imag) * dt[:, None]
        pos = (lambda x, dt: x.to(dt))(torch.arange(L), log_dt.dtype)
        P = torch.exp((A * dt[:, None])[:, :, None] * pos[None, None, :])
        K = 2.0 * torch.einsum("dn,dnl->dl", C, P).real
        L2 = 2 * L
        u_t = (lambda x, *d: x.permute(*d))(u, 0, 2, 1)
        Kf = (lambda x, *a, **k: torch.fft.rfft(x.float(), *a, **k))(K, L2)
        Uf = (lambda x, *a, **k: torch.fft.rfft(x.float(), *a, **k))(u_t, L2)
        y = (lambda x, *a, **k: torch.fft.irfft(x, *a, **k).to(torch.bfloat16))(Uf * Kf[None, :, :], L2)[:, :, :L]
        y = (lambda x, *d: x.permute(*d))(y, 0, 2, 1)
        return y + u * D_skip[None, None, :]

    def _B_ref(x, w_r, w_i):
        B, S, D = x.shape
        X = (lambda x, axes=(-2,-1): torch.fft.rfft2(x.float(), dim=axes))(x, axes=(-2, -1))
        W = w_r + 1j * w_i
        X = X * W
        y = (lambda x, s, axes=(-2,-1): torch.fft.irfft2(x, s=s, dim=axes).to(torch.bfloat16))(X, (S, D), axes=(-2, -1))
        return y

    x = A_u
    x = x + _A_ref(_layernorm(x, axis=-1), A_log_A_real, A_A_imag, A_C_real, A_C_imag, A_log_dt, A_D_skip)
    x = x + _B_ref(_layernorm(x, axis=-1), B_w_r, B_w_i)
    x = x + _A_ref(_layernorm(x, axis=-1), A_log_A_real, A_A_imag, A_C_real, A_C_imag, A_log_dt, A_D_skip)
    x = x + _B_ref(_layernorm(x, axis=-1), B_w_r, B_w_i)
    return x
```

```asm
; @launch grid=(256,1,1) block=(512,1,1) lds=123552
.amdgcn_target "amdgcn-amd-amdhsa--gfx950"
.text
.globl interleave_layers__ssm_conv_s4d__spectral_gfnet__prompt_kernel
.p2align 8
.type interleave_layers__ssm_conv_s4d__spectral_gfnet__prompt_kernel,@function
interleave_layers__ssm_conv_s4d__spectral_gfnet__prompt_kernel:
    s_cmp_ge_u32 s2, 256
    s_cbranch_scc1 L_end
    s_load_dwordx2 s[16:17], s[0:1], 0
    s_load_dwordx2 s[40:41], s[0:1], 96
    s_load_dwordx8 s[20:27], s[0:1], 16
    s_getpc_b64 s[12:13]
L_pc:
    v_lshlrev_b32 v117, 5, v0
    v_min_u32 v117, L_code_end-L_pc-4, v117
    global_load_dword v103, v117, s[12:13]
    s_load_dwordx2 s[18:19], s[0:1], 8
    s_load_dwordx2 s[28:29], s[0:1], 48
    s_load_dwordx8 s[32:39], s[0:1], 64
    s_and_b32 s66, s2, 7
    s_lshl_b32 s66, s66, 5
    s_lshr_b32 s67, s2, 3
    s_add_u32 s3, s66, s67
    v_lshrrev_b32 v118, 6, v0
    v_bfe_u32 v114, v0, 4, 2
    v_and_b32 v113, 15, v0
    v_readfirstlane_b32 s4, v118
    v_lshlrev_b32 v117, 7, v114
    v_lshl_add_u32 v166, v113, 1, v117
    s_lshl_b32 s68, s3, 10
    v_lshl_add_u32 v118, v118, 18, s68
    v_lshl_add_u32 v118, v113, 5, v118
    v_bfe_u32 v119, v0, 5, 1
    v_lshl_add_u32 v118, v119, 9, v118
    v_and_b32 v119, 16, v0
    v_add_u32 v119, v118, v119
    v_lshlrev_b32 v151, 4, v0
    s_mov_b32 s14, 2139193217
    v_mov_b32 v126, 0
    s_lshl_b32 s47, s3, 13
    s_add_u32 s89, s47, 6291456
    v_mov_b32 v44, s14
    v_mov_b32 v45, s14
    v_mov_b32 v46, s14
    v_mov_b32 v47, s14
    s_lshr_b32 s66, s3, 2
    s_and_b32 s67, s66, 15
    s_lshr_b32 s66, s66, 4
    s_lshl_b32 s66, s66, 6
    s_add_u32 s67, s67, s66
    s_and_b32 s66, s3, 1
    s_lshl_b32 s66, s66, 5
    s_add_u32 s67, s67, s66
    s_and_b32 s66, s3, 2
    s_lshl_b32 s66, s66, 7
    s_add_u32 s67, s67, s66
    s_and_b32 s66, s4, 2
    s_lshl_b32 s66, s66, 3
    s_add_u32 s67, s67, s66
    s_lshl_b32 s69, s67, 8
    s_and_b32 s66, s4, 1
    s_lshl_b32 s66, s66, 7
    s_add_u32 s69, s69, s66
    v_and_b32 v112, 63, v0
    v_lshl_add_u32 v124, v112, 1, s69
    s_lshl_b32 s67, s67, 1
    v_mov_b32 v125, s67
    s_waitcnt lgkmcnt(0)
    global_load_dwordx4 v[72:75], v119, s[16:17]
    s_lshl_b32 s88, s3, 6
    s_lshr_b32 s66, s3, 1
    s_lshl_b32 s66, s66, 14
    s_and_b32 s67, s3, 1
    s_lshl_b32 s67, s67, 5
    s_add_u32 s73, s66, s67
    s_mov_b32 s5, 0
    v_lshlrev_b32 v2, 4, v112
    v_and_b32 v115, 1, v112
    s_lshl_b32 s68, s4, 8
    s_add_u32 s68, s68, s3
    s_lshl_b32 s68, s68, 10
    s_add_u32 s44, s73, 4194304
    s_add_u32 s45, s88, 6291456
    s_add_u32 s46, s47, 10485760
    s_add_u32 s56, s47, 20971520
    s_lshl_b32 s66, s3, 5
    s_add_u32 s57, s66, 20971520
    s_add_u32 s76, s88, 2097152
    s_lshl_b32 s77, s47, 1
    s_add_u32 s77, s77, 2097152
    s_mul_i32 s69, s3, 4112
    s_lshl_b32 s6, s4, 10
    s_and_b32 s7, s4, 4
    s_lshl_b32 s7, s7, 4
    s_or_b32 s6, s6, s7
    v_xor_b32 v16, s6, v2
    v_mul_u32_u24 v122, 4160, v115
    v_lshrrev_b32 v117, 1, v0
    v_lshlrev_b32 v117, 2, v117
    v_xor_b32 v17, v117, v122
    v_lshrrev_b32 v117, 2, v0
    v_and_b32 v118, 3, v0
    v_lshlrev_b32 v118, 4, v118
    v_lshl_add_u32 v1, v117, 14, v118
    v_lshlrev_b32 v119, 7, v118
    v_lshlrev_b32 v118, 1, v118
    v_and_b32 v118, 64, v118
    v_lshl_add_u32 v139, v117, 3, v119
    v_xor_b32 v139, v139, v118
    v_add_u32 v132, 4, v139
    v_lshlrev_b32 v118, 4, v0
    v_and_b32 v118, 48, v118
    v_lshl_add_u32 v140, v117, 15, v118
    v_lshrrev_b32 v117, 3, v112
    v_mul_u32_u24 v117, 2080, v117
    v_bfe_u32 v118, v112, 2, 1
    v_lshl_add_u32 v117, v118, 10, v117
    v_and_b32 v119, 3, v112
    v_lshl_add_u32 v117, v119, 2, v117
    s_bfe_u32 s66, s4, 0x10001
    s_mul_i32 s66, s66, 33280
    s_and_b32 s67, s4, 1
    s_mul_i32 s67, s67, 16640
    s_add_u32 s66, s66, s67
    s_add_u32 s66, s66, 56992
    v_add_u32 v141, s66, v117
    v_bfe_u32 v117, v112, 1, 3
    v_lshl_add_u32 v117, v114, 5, v117
    s_and_b32 s6, s4, 3
    s_lshl_b32 s7, s6, 3
    s_lshr_b32 s66, s4, 2
    s_lshl_b32 s67, s66, 7
    s_add_u32 s7, s7, s67
    v_add_u32 v117, s7, v117
    v_lshlrev_b32 v118, 4, v115
    v_lshl_add_u32 v18, v117, 6, v118
    s_mov_b32 s8, s40
    s_mov_b32 s9, s41
    s_mov_b32 s10, 23068672
    s_mov_b32 s11, 0x00020000
    buffer_load_dword v152, v126, s[8:11], 0 offen sc1
    buffer_store_dwordx4 v[44:47], v151, s[8:11], s89 offen sc1
    global_load_short_d16_hi v153, v124, s[18:19]
    global_load_short_d16_hi v154, v124, s[20:21]
    global_load_short_d16_hi v155, v124, s[22:23]
    global_load_short_d16_hi v156, v124, s[24:25]
    global_load_short_d16_hi v157, v125, s[26:27]
    v_lshrrev_b32 v117, 3, v113
    v_xor_b32 v117, v117, v114
    v_and_b32 v117, 1, v117
    v_bfe_u32 v118, v113, 1, 2
    v_lshl_add_u32 v117, v117, 2, v118
    v_lshlrev_b32 v118, 4, v113
    v_and_b32 v118, 16, v118
    v_mov_b32 v119, 0x3f80
    v_lshlrev_b32 v118, v118, v119
    s_mov_b32 s49, 0
    s_mov_b32 s50, 0
    v_cmp_eq_u32_e64 s[52:53], 0, v117
    s_mov_b32 s48, s52
    s_mov_b32 s51, s53
    v_cndmask_b32_e64 v64, 0, v118, s[48:49]
    v_cndmask_b32_e64 v68, 0, v118, s[50:51]
    v_cmp_eq_u32_e64 s[52:53], 1, v117
    s_mov_b32 s48, s52
    s_mov_b32 s51, s53
    v_cndmask_b32_e64 v65, 0, v118, s[48:49]
    v_cndmask_b32_e64 v69, 0, v118, s[50:51]
    v_cmp_eq_u32_e64 s[52:53], 2, v117
    s_mov_b32 s48, s52
    s_mov_b32 s51, s53
    v_cndmask_b32_e64 v66, 0, v118, s[48:49]
    v_cndmask_b32_e64 v70, 0, v118, s[50:51]
    v_cmp_eq_u32_e64 s[52:53], 3, v117
    s_mov_b32 s48, s52
    s_mov_b32 s51, s53
    v_cndmask_b32_e64 v67, 0, v118, s[48:49]
    v_cndmask_b32_e64 v71, 0, v118, s[50:51]
    s_add_u32 s36, s36, s68
    s_addc_u32 s37, s37, 0
    s_add_u32 s32, s32, s69
    s_addc_u32 s33, s33, 0
    s_add_u32 s34, s34, s69
    s_addc_u32 s35, s35, 0
    s_mov_b32 s54, 0x00010001
    s_mov_b32 s55, 0x00010001
    s_mov_b32 s78, 0x55555555
    s_mov_b32 s79, 0x55555555
    s_mov_b32 s62, 0x05040100
    s_mov_b32 s63, 0x07060302
    s_lshr_b32 s6, s4, 2
    s_and_b32 s7, s4, 3
    v_lshrrev_b32 v117, 1, v114
    v_mul_u32_u24 v117, 2080, v117
    v_and_b32 v118, 1, v114
    v_lshl_add_u32 v117, v118, 10, v117
    v_lshl_add_u32 v117, v113, 4, v117
    s_mul_i32 s66, s6, 33280
    s_add_u32 s66, s66, 57760
    v_add_u32 v143, s66, v117
    s_lshl_b32 s67, s7, 8
    s_sub_u32 s67, s67, 768
    v_add_u32 v142, s67, v143
    v_cmp_gt_u32_e64 s[48:49], 32, v112
    s_mul_i32 s69, s6, 3328
    s_add_u32 s69, s69, 47104
    v_lshrrev_b32 v117, 1, v114
    v_lshlrev_b32 v117, 7, v117
    v_lshl_add_u32 v117, v113, 3, v117
    v_and_b32 v118, 1, v114
    v_lshl_add_u32 v117, v118, 2, v117
    v_lshl_add_u32 v144, v117, 2, s69
    v_add_u32 v131, 8, v144
    s_cmp_lg_u32 s7, 1
    s_cbranch_scc1 L_nott1
    v_lshlrev_b32 v117, 4, v113
    v_lshlrev_b32 v118, 3, v113
    v_cndmask_b32_e64 v117, v118, v117, s[48:49]
    v_lshl_add_u32 v117, v114, 8, v117
    s_add_u32 s66, s69, 1024
    v_add_u32 v144, s66, v117
    v_mov_b32 v117, 128
    v_cndmask_b32_e64 v117, v117, 8, s[48:49]
    v_add_u32 v131, v144, v117
L_nott1:
    v_lshrrev_b32 v118, 1, v113
    v_lshl_add_u32 v118, v114, 5, v118
    v_add_u32 v118, v118, v115
    v_lshlrev_b32 v118, 1, v118
    v_mul_u32_u24 v119, 200, v115
    v_sub_u32 v118, v119, v118
    s_mul_i32 s66, s6, 1616
    s_add_u32 s66, s66, 53848
    v_add_u32 v128, s66, v118
    s_and_b32 s66, s7, 1
    s_lshl_b32 s66, s66, 10
    s_mul_i32 s67, s6, 17920
    s_add_u32 s67, s67, 56992
    s_add_u32 s66, s66, s67
    s_add_u32 s66, s66, 64
    v_add_u32 v145, s66, v2
    v_lshlrev_b32 v117, 3, v112
    s_add_u32 s66, s69, 2040
    v_sub_u32 v147, s66, v117
    s_cmp_lg_u32 s7, 1
    s_cbranch_scc1 L_notr1
    s_add_u32 s66, s69, 1520
    v_sub_u32 v117, s66, v2
    v_lshlrev_b32 v118, 5, v112
    s_add_u32 s66, s69, 2016
    v_sub_u32 v118, s66, v118
    v_cndmask_b32_e64 v147, v118, v117, s[48:49]
L_notr1:
    v_and_b32 v117, 7, v112
    v_bfe_u32 v118, v112, 3, 1
    v_lshlrev_b32 v118, 4, v118
    s_add_u32 s66, s67, 32
    v_add_u32 v118, s66, v118
    v_lshl_add_u32 v129, v117, 1, v118
    v_mul_u32_u24 v117, 2240, v117
    v_add_u32 v130, v117, v118
    s_mul_i32 s66, s6, 5280
    s_add_u32 s66, s66, 92832
    v_mul_u32_u24 v117, 1344, v114
    v_and_b32 v117, 0xff80, v117
    v_lshl_add_u32 v117, v113, 4, v117
    v_add_u32 v146, s66, v117
    s_cmp_lg_u32 s7, 1
    s_cbranch_scc1 L_notz1
    v_bfe_u32 v117, v112, 2, 3
    v_mul_u32_u24 v117, 2240, v117
    v_and_b32 v118, 3, v112
    v_lshl_add_u32 v117, v118, 4, v117
    v_add_u32 v117, 2112, v117
    v_bfe_u32 v118, v112, 1, 3
    v_mul_u32_u24 v118, 2240, v118
    v_lshl_add_u32 v118, v115, 4, v118
    v_cndmask_b32_e64 v117, v118, v117, s[48:49]
    v_add_u32 v146, s67, v117
L_notz1:
    s_mul_i32 s66, s6, 1616
    s_add_u32 s66, s66, 53760
    s_and_b32 s67, s7, 1
    s_mul_i32 s67, s67, 592
    s_add_u32 s66, s66, s67
    v_add_u32 v117, s66, v2
    v_mov_b32 v184, 0
    v_mov_b32 v185, 0
    v_mov_b32 v186, 0
    v_mov_b32 v187, 0
    ds_write_b128 v117, v[184:187]
    v_bfe_u32 v117, v112, 1, 1
    v_cmp_eq_u32_e64 s[48:49], 1, v117
    v_mul_u32_u24 v118, 5280, v117
    v_lshl_add_u32 v118, v114, 4, v118
    v_lshl_add_u32 v118, v115, 9, v118
    v_bfe_u32 v119, v112, 2, 2
    v_lshl_add_u32 v118, v119, 2, v118
    s_mul_i32 s66, s7, 1344
    s_and_b32 s66, s66, 0xff80
    s_lshl_b32 s67, s6, 6
    s_add_u32 s66, s66, s67
    s_add_u32 s66, s66, 93088
    v_add_u32 v4, s66, v118
    v_mov_b32 v118, 0x05040100
    v_mov_b32 v119, 0x03020706
    v_cndmask_b32_e64 v19, v118, v119, s[48:49]
    s_cmp_ge_u32 s4, 8
    s_cbranch_scc1 L_noconvaddr
    s_lshr_b32 s6, s4, 1
    s_and_b32 s7, s4, 1
    v_and_b32 v117, 7, v113
    v_lshrrev_b32 v118, 3, v113
    v_mul_u32_u24 v119, 2240, v117
    v_sub_u32 v120, v114, v118
    v_lshlrev_b32 v120, 4, v120
    v_sub_u32 v119, v120, v119
    s_mul_i32 s66, s6, 17920
    s_lshl_b32 s67, s7, 5
    s_sub_u32 s66, s66, s67
    s_add_u32 s66, s66, 72720
    v_add_u32 v5, s66, v119
    v_mul_u32_u24 v119, 1344, v114
    v_and_b32 v119, 0xff80, v119
    v_lshl_add_u32 v119, v113, 4, v119
    s_mul_i32 s66, s6, 5280
    s_add_u32 s66, s66, 92848
    v_add_u32 v6, s66, v119
    v_lshl_add_u32 v119, v113, 1, v114
    v_add_u32 v119, 61, v119
    v_and_b32 v120, 3, v119
    v_mul_u32_u24 v120, 1344, v120
    v_and_b32 v120, 0xff80, v120
    v_lshrrev_b32 v121, 2, v119
    v_lshl_add_u32 v120, v121, 4, v120
    s_sub_u32 s67, s66, 8
    v_add_u32 v162, s67, v120
    v_add_u32 v119, 1, v119
    v_and_b32 v120, 3, v119
    v_mul_u32_u24 v120, 1344, v120
    v_and_b32 v120, 0xff80, v120
    v_lshrrev_b32 v121, 2, v119
    v_lshl_add_u32 v120, v121, 4, v120
    s_sub_u32 s67, s66, 16
    v_add_u32 v163, s67, v120
    v_lshlrev_b32 v119, 2, v114
    v_lshlrev_b32 v120, 1, v113
    v_sub_u32 v119, v119, v120
    s_sub_u32 s67, 31, s7
    v_add_u32 v119, s67, v119
    v_and_b32 v120, 3, v119
    v_mul_u32_u24 v120, 398, v120
    v_lshl_add_u32 v119, v119, 1, v120
    s_mul_i32 s66, s6, 1616
    s_add_u32 s66, s66, 53768
    v_add_u32 v164, s66, v119
    v_mul_u32_u24 v119, 520, v117
    v_lshl_add_u32 v119, v114, 6, v119
    v_lshl_add_u32 v119, v118, 2, v119
    s_mul_i32 s66, s6, 4160
    s_lshl_b32 s67, s7, 8
    s_add_u32 s66, s66, s67
    s_add_u32 s66, s66, 103392
    v_add_u32 v7, s66, v119
L_noconvaddr:
    v_bfe_u32 v117, v112, 1, 5
    v_lshlrev_b32 v117, 4, v117
    v_lshl_add_u32 v117, v115, 3, v117
    s_mul_i32 s66, s4, 520
    s_add_u32 s66, s66, 103392
    v_add_u32 v8, s66, v117
    v_mov_b32 v11, 0
    v_mov_b32 v9, 0
    v_mov_b32 v10, 0
    v_mov_b32 v12, 0
    v_mov_b32 v13, 0
    v_mov_b32 v148, 0
    v_mov_b32 v149, 0
    v_mov_b32 v133, 0
    s_cmp_lt_u32 s4, 0
    s_cbranch_scc1 L_nowoff
    v_and_b32 v117, 7, v112
    s_and_b32 s6, s4, 1
    s_lshl_b32 s6, s6, 3
    v_add_u32 v118, s6, v117
    s_and_b32 s66, s4, 2
    s_lshl_b32 s66, s66, 6
    v_lshl_add_u32 v120, v114, 5, v118
    v_add_u32 v120, s66, v120
    v_cmp_eq_u32_e64 s[48:49], 0, v120
    v_cmp_eq_u32_e64 s[50:51], 0, v118
    v_mov_b32 v121, 256
    v_sub_u32 v122, v121, v120
    v_add_u32 v123, 16, v120
    v_cndmask_b32_e64 v120, v120, v121, s[48:49]
    v_cndmask_b32_e64 v122, v122, v123, s[50:51]
    v_bfe_u32 v121, v112, 3, 1
    v_mul_u32_u24 v123, 2056, v121
    v_lshl_add_u32 v148, v120, 1, v123
    v_lshl_add_u32 v149, v122, 1, v123
    v_lshrrev_b32 v117, 3, v112
    v_lshl_add_u32 v117, v115, 3, v117
    v_bfe_u32 v118, v112, 1, 2
    v_lshl_add_u32 v117, v118, 4, v117
    s_lshl_b32 s66, s4, 10
    s_or_b32 s66, s66, 64
    v_lshlrev_b32 v117, 4, v117
    v_xor_b32 v150, v117, s66
L_nowoff:
    s_waitcnt vmcnt(7)
    v_mfma_f32_16x16x32_bf16 v[20:23], v[72:75], v[64:67], 0
    v_mfma_f32_16x16x32_bf16 v[24:27], v[72:75], v[68:71], 0
    s_nop 6
    v_readfirstlane_b32 s60, v20
    s_nop 1
    v_mov_b32 v3, s60
    v_pk_add_f32 v[20:21], v[20:21], s[60:61] op_sel_hi:[1,0] neg_lo:[0,1] neg_hi:[0,1]
    v_pk_add_f32 v[22:23], v[22:23], s[60:61] op_sel_hi:[1,0] neg_lo:[0,1] neg_hi:[0,1]
    v_pk_add_f32 v[24:25], v[24:25], s[60:61] op_sel_hi:[1,0] neg_lo:[0,1] neg_hi:[0,1]
    v_pk_add_f32 v[26:27], v[26:27], s[60:61] op_sel_hi:[1,0] neg_lo:[0,1] neg_hi:[0,1]
    v_mov_b32 v165, 0x3727c5ac
    v_pk_add_f32 v[112:113], v[20:21], v[22:23]
    v_pk_mul_f32 v[114:115], v[20:21], v[20:21]
    v_pk_add_f32 v[112:113], v[112:113], v[24:25]
    v_pk_fma_f32 v[114:115], v[22:23], v[22:23], v[114:115]
    v_pk_add_f32 v[112:113], v[112:113], v[26:27]
    v_pk_fma_f32 v[114:115], v[24:25], v[24:25], v[114:115]
    v_add_f32 v112, v112, v113
    v_pk_fma_f32 v[114:115], v[26:27], v[26:27], v[114:115]
    v_add_f32 v114, v114, v115
    v_add_f32_dpp v112, v112, v112 row_ror:8 row_mask:0xf bank_mask:0xf
    s_nop 0
    v_add_f32_dpp v114, v114, v114 row_ror:8 row_mask:0xf bank_mask:0xf
    v_add_f32_dpp v112, v112, v112 row_ror:4 row_mask:0xf bank_mask:0xf
    s_nop 0
    v_add_f32_dpp v114, v114, v114 row_ror:4 row_mask:0xf bank_mask:0xf
    v_add_f32_dpp v112, v112, v112 row_ror:2 row_mask:0xf bank_mask:0xf
    s_nop 0
    v_add_f32_dpp v114, v114, v114 row_ror:2 row_mask:0xf bank_mask:0xf
    v_add_f32_dpp v112, v112, v112 row_ror:1 row_mask:0xf bank_mask:0xf
    s_nop 0
    v_add_f32_dpp v114, v114, v114 row_ror:1 row_mask:0xf bank_mask:0xf
    v_add_f32_dpp v112, v112, v112 row_bcast:15 row_mask:0xa bank_mask:0xf
    s_nop 0
    v_add_f32_dpp v114, v114, v114 row_bcast:15 row_mask:0xa bank_mask:0xf
    v_add_f32_dpp v112, v112, v112 row_bcast:31 row_mask:0xc bank_mask:0xf
    s_nop 0
    v_add_f32_dpp v114, v114, v114 row_bcast:31 row_mask:0xc bank_mask:0xf
    v_mul_f32 v112, 0x3b000000, v112
    v_mul_f32 v114, 0x3b000000, v114
    v_fma_f32 v114, -v112, v112, v114
    v_max_f32 v114, 0, v114
    v_add_f32 v114, 0x3727c5ac, v114
    v_rsq_f32 v114, v114
    v_readlane_b32 s60, v112, 63
    v_mul_f32 v113, v112, v114
    v_readlane_b32 s58, v114, 63
    v_readlane_b32 s59, v113, 63
    s_nop 1
    v_pk_fma_f32 v[248:249], v[20:21], s[58:59], s[58:59] op_sel:[0,0,1] op_sel_hi:[1,0,1] neg_lo:[0,0,1] neg_hi:[0,0,1]
    v_pk_fma_f32 v[250:251], v[22:23], s[58:59], s[58:59] op_sel:[0,0,1] op_sel_hi:[1,0,1] neg_lo:[0,0,1] neg_hi:[0,0,1]
    v_pk_fma_f32 v[252:253], v[24:25], s[58:59], s[58:59] op_sel:[0,0,1] op_sel_hi:[1,0,1] neg_lo:[0,0,1] neg_hi:[0,0,1]
    v_pk_fma_f32 v[254:255], v[26:27], s[58:59], s[58:59] op_sel:[0,0,1] op_sel_hi:[1,0,1] neg_lo:[0,0,1] neg_hi:[0,0,1]
    s_branch L_LNt
L_LN:
    v_pk_mul_f32 v[112:113], v[20:21], v[20:21]
    v_pk_mul_f32 v[114:115], v[24:25], v[24:25]
    v_pk_fma_f32 v[112:113], v[22:23], v[22:23], v[112:113]
    v_pk_fma_f32 v[114:115], v[26:27], v[26:27], v[114:115]
    v_pk_add_f32 v[112:113], v[112:113], v[114:115]
    v_add_f32 v112, v112, v113
    s_nop 1
    v_add_f32_dpp v112, v112, v112 row_ror:8 row_mask:0xf bank_mask:0xf
    s_nop 1
    v_add_f32_dpp v112, v112, v112 row_ror:4 row_mask:0xf bank_mask:0xf
    s_nop 1
    v_add_f32_dpp v112, v112, v112 row_ror:2 row_mask:0xf bank_mask:0xf
    s_nop 1
    v_add_f32_dpp v112, v112, v112 row_ror:1 row_mask:0xf bank_mask:0xf
    s_nop 1
    v_add_f32_dpp v112, v112, v112 row_bcast:15 row_mask:0xa bank_mask:0xf
    s_nop 1
    v_add_f32_dpp v112, v112, v112 row_bcast:31 row_mask:0xc bank_mask:0xf
    v_fmamk_f32 v112, v112, 0x3b000000, v165
    v_rsq_f32 v112, v112
    s_mov_b32 s60, 0
    v_readlane_b32 s58, v112, 63
    s_nop 1
    v_pk_mul_f32 v[248:249], v[20:21], s[58:59] op_sel_hi:[1,0]
    v_pk_mul_f32 v[250:251], v[22:23], s[58:59] op_sel_hi:[1,0]
    v_pk_mul_f32 v[252:253], v[24:25], s[58:59] op_sel_hi:[1,0]
    v_pk_mul_f32 v[254:255], v[26:27], s[58:59] op_sel_hi:[1,0]
L_LNt:
    v_cvt_pk_bf16_f32 v116, v248, v249
    v_cvt_pk_bf16_f32 v117, v250, v251
    v_cvt_pk_bf16_f32 v118, v252, v253
    v_cvt_pk_bf16_f32 v119, v254, v255
    ds_write_b128 v16, v[116:119] offset:22528
    s_cmp_lg_u32 s5, 0
    s_cbranch_scc1 L_lnw
    s_waitcnt vmcnt(5)
L_lnw:
    s_waitcnt lgkmcnt(0)
    s_barrier
    s_cmp_eq_u32 s5, 0
    s_cbranch_scc1 L_tail0
    ds_read2st64_b32 v[120:121], v17 offset0:88 offset1:92
    ds_read2st64_b32 v[122:123], v17 offset0:96 offset1:100
    s_waitcnt lgkmcnt(0)
    buffer_store_dwordx4 v[120:123], v1, s[8:11], s45 offen sc1
    s_add_u32 s44, s44, 2097152
    s_add_u32 s45, s45, 2097152
    s_add_u32 s46, s46, 2097152
    s_waitcnt lgkmcnt(0)
    s_sleep 22
    buffer_load_dwordx4 v[48:51], v18, s[8:11], s44 offen sc1
    s_waitcnt vmcnt(0)
    v_mov_b32_dpp v112, v48 quad_perm:[2,3,0,1] row_mask:0xf bank_mask:0xf
    v_mov_b32_dpp v113, v49 quad_perm:[2,3,0,1] row_mask:0xf bank_mask:0xf
    v_mov_b32_dpp v114, v50 quad_perm:[2,3,0,1] row_mask:0xf bank_mask:0xf
    v_mov_b32_dpp v115, v51 quad_perm:[2,3,0,1] row_mask:0xf bank_mask:0xf
    v_perm_b32 v112, v112, v48, v19
    ds_write_b32 v4, v112 offset:0
    v_perm_b32 v113, v113, v49, v19
    ds_write_b32 v4, v113 offset:128
    v_perm_b32 v114, v114, v50, v19
    ds_write_b32 v4, v114 offset:256
    v_perm_b32 v115, v115, v51, v19
    ds_write_b32 v4, v115 offset:384
    v_cmp_eq_u32 vcc, s14, v48
    v_cmp_eq_u32_e64 s[48:49], s14, v49
    v_cmp_eq_u32_e64 s[50:51], s14, v50
    v_cmp_eq_u32_e64 s[52:53], s14, v51
    s_or_b64 vcc, vcc, s[48:49]
    s_or_b64 s[50:51], s[50:51], s[52:53]
    s_or_b64 s[50:51], vcc, s[50:51]
    s_cbranch_scc0 L_pollok0
    s_mov_b64 exec, s[50:51]
    s_mov_b32 s15, 1000000
L_poll0:
    buffer_load_dwordx4 v[48:51], v18, s[8:11], s44 offen sc1
    s_waitcnt vmcnt(0)
    v_cmp_eq_u32 vcc, s14, v48
    v_cmp_eq_u32_e64 s[48:49], s14, v49
    v_cmp_eq_u32_e64 s[50:51], s14, v50
    v_cmp_eq_u32_e64 s[52:53], s14, v51
    s_or_b64 vcc, vcc, s[48:49]
    s_or_b64 s[50:51], s[50:51], s[52:53]
    s_or_b64 exec, vcc, s[50:51]
    s_cbranch_scc0 L_polld0
    s_sub_u32 s15, s15, 1
    s_cbranch_scc0 L_poll0
    s_mov_b64 exec, -1
    v_mov_b32 v103, 4
    global_store_dword v103, v103, s[38:39]
L_polld0:
    s_mov_b64 exec, -1
    v_mov_b32_dpp v112, v48 quad_perm:[2,3,0,1] row_mask:0xf bank_mask:0xf
    v_mov_b32_dpp v113, v49 quad_perm:[2,3,0,1] row_mask:0xf bank_mask:0xf
    v_mov_b32_dpp v114, v50 quad_perm:[2,3,0,1] row_mask:0xf bank_mask:0xf
    v_mov_b32_dpp v115, v51 quad_perm:[2,3,0,1] row_mask:0xf bank_mask:0xf
    v_perm_b32 v112, v112, v48, v19
    ds_write_b32 v4, v112 offset:0
    v_perm_b32 v113, v113, v49, v19
    ds_write_b32 v4, v113 offset:128
    v_perm_b32 v114, v114, v50, v19
    ds_write_b32 v4, v114 offset:256
    v_perm_b32 v115, v115, v51, v19
    ds_write_b32 v4, v115 offset:384
L_pollok0:
    s_branch L_it1w
L_tail0:
    ds_read2st64_b32 v[120:121], v139 offset0:88 offset1:92
    ds_read2st64_b32 v[124:125], v132 offset0:88 offset1:92
    v_add_u32 v122, 0x9e3779b9, v152
    v_add_u32 v126, 0x9e3779b9, v152
    v_xor_b32 v123, 0x5bd1e995, v122
    v_xor_b32 v127, 0x5bd1e995, v122
    v_readfirstlane_b32 s42, v122
    v_readfirstlane_b32 s43, v123
    s_waitcnt lgkmcnt(0)
    s_add_u32 s66, s76, 16384
    buffer_store_dwordx4 v[120:123], v140, s[8:11], s76 offen sc1
    buffer_store_dwordx4 v[124:127], v140, s[8:11], s66 offen sc1
    s_waitcnt vmcnt(2)
    v_mul_f32 v157, 0x3fb8aa3b, v157
    v_mul_f32 v153, 0x3fb8aa3b, v153
    v_exp_f32 v157, v157
    v_exp_f32 v153, v153
    v_and_b32 v102, 16, v18
    v_add_u32 v102, v102, v18
    v_cvt_pk_bf16_f32 v157, 0, v157
    v_cvt_pk_bf16_f32 v153, 0, v153
    v_mul_f32 v154, v154, v157
    v_mul_f32 v153, v153, v157
    v_add_f32 v157, v157, v157
    v_mul_f32 v154, 0x3e22f983, v154
    v_mul_f32 v153, 0xbfb8aa3b, v153
    v_mul_f32 v64, v155, v157
    v_mul_f32 v65, v156, v157
    s_cmp_ge_u32 s4, 4
    s_cbranch_scc1 L_sideY
    v_mul_f32 v117, 0x3f800000, v154
    v_mul_f32 v116, 0x3f800000, v153
    v_fract_f32 v117, v117
    v_exp_f32 v116, v116
    v_cos_f32 v72, v117
    v_sin_f32 v73, v117
    s_nop 0
    v_pk_mul_f32 v[72:73], v[72:73], v[116:117] op_sel_hi:[1,0]
    v_mul_f32 v117, 0x43000000, v154
    v_mul_f32 v116, 0x43000000, v153
    v_fract_f32 v117, v117
    v_exp_f32 v116, v116
    v_cos_f32 v86, v117
    v_sin_f32 v87, v117
    s_nop 0
    v_pk_mul_f32 v[86:87], v[86:87], v[116:117] op_sel_hi:[1,0]
    v_pk_mul_f32 v[120:121], v[72:73], v[72:73] op_sel_hi:[1,0]
    v_pk_mul_f32 v[122:123], v[64:65], v[86:87] op_sel_hi:[1,0]
    v_pk_fma_f32 v[74:75], v[72:73], v[72:73], v[120:121] op_sel:[1,1,0] op_sel_hi:[0,1,1] neg_lo:[0,1,0]
    v_pk_fma_f32 v[66:67], v[64:65], v[86:87], v[122:123] op_sel:[1,1,0] op_sel_hi:[0,1,1] neg_lo:[0,1,0]
    v_pk_mul_f32 v[120:121], v[74:75], v[72:73] op_sel_hi:[1,0]
    v_pk_mul_f32 v[122:123], v[74:75], v[74:75] op_sel_hi:[1,0]
    v_cvt_pk_bf16_f32 v124, v64, v65
    v_cvt_pk_bf16_f32 v125, v66, v67
    ds_write2_b32 v141, v124, v125 offset0:0 offset1:32
    v_pk_fma_f32 v[76:77], v[74:75], v[72:73], v[120:121] op_sel:[1,1,0] op_sel_hi:[0,1,1] neg_lo:[0,1,0]
    v_pk_fma_f32 v[78:79], v[74:75], v[74:75], v[122:123] op_sel:[1,1,0] op_sel_hi:[0,1,1] neg_lo:[0,1,0]
    v_pk_mul_f32 v[120:121], v[64:65], v[72:73] op_sel_hi:[1,0]
    v_pk_mul_f32 v[122:123], v[66:67], v[72:73] op_sel_hi:[1,0]
    v_pk_fma_f32 v[88:89], v[64:65], v[72:73], v[120:121] op_sel:[1,1,0] op_sel_hi:[0,1,1] neg_lo:[0,1,0]
    v_pk_fma_f32 v[90:91], v[66:67], v[72:73], v[122:123] op_sel:[1,1,0] op_sel_hi:[0,1,1] neg_lo:[0,1,0]
    v_pk_mul_f32 v[120:121], v[78:79], v[72:73] op_sel_hi:[1,0]
    v_pk_mul_f32 v[122:123], v[78:79], v[74:75] op_sel_hi:[1,0]
    v_cvt_pk_bf16_f32 v126, v88, v89
    v_cvt_pk_bf16_f32 v127, v90, v91
    ds_write2_b32 v141, v126, v127 offset0:4 offset1:36
    v_pk_fma_f32 v[80:81], v[78:79], v[72:73], v[120:121] op_sel:[1,1,0] op_sel_hi:[0,1,1] neg_lo:[0,1,0]
    v_pk_fma_f32 v[82:83], v[78:79], v[74:75], v[122:123] op_sel:[1,1,0] op_sel_hi:[0,1,1] neg_lo:[0,1,0]
    v_pk_mul_f32 v[120:121], v[78:79], v[76:77] op_sel_hi:[1,0]
    v_pk_mul_f32 v[122:123], v[66:67], v[86:87] op_sel_hi:[1,0]
    v_pk_fma_f32 v[84:85], v[78:79], v[76:77], v[120:121] op_sel:[1,1,0] op_sel_hi:[0,1,1] neg_lo:[0,1,0]
    v_pk_fma_f32 v[68:69], v[66:67], v[86:87], v[122:123] op_sel:[1,1,0] op_sel_hi:[0,1,1] neg_lo:[0,1,0]
    v_pk_mul_f32 v[120:121], v[64:65], v[74:75] op_sel_hi:[1,0]
    v_pk_mul_f32 v[122:123], v[66:67], v[74:75] op_sel_hi:[1,0]
    v_pk_fma_f32 v[92:93], v[64:65], v[74:75], v[120:121] op_sel:[1,1,0] op_sel_hi:[0,1,1] neg_lo:[0,1,0]
    v_pk_fma_f32 v[94:95], v[66:67], v[74:75], v[122:123] op_sel:[1,1,0] op_sel_hi:[0,1,1] neg_lo:[0,1,0]
    v_pk_mul_f32 v[120:121], v[64:65], v[76:77] op_sel_hi:[1,0]
    v_pk_mul_f32 v[122:123], v[66:67], v[76:77] op_sel_hi:[1,0]
    v_cvt_pk_bf16_f32 v124, v68, v69
    v_cvt_pk_bf16_f32 v125, v92, v93
    ds_write2_b32 v141, v124, v125 offset0:64 offset1:8
    v_pk_fma_f32 v[96:97], v[64:65], v[76:77], v[120:121] op_sel:[1,1,0] op_sel_hi:[0,1,1] neg_lo:[0,1,0]
    v_pk_fma_f32 v[98:99], v[66:67], v[76:77], v[122:123] op_sel:[1,1,0] op_sel_hi:[0,1,1] neg_lo:[0,1,0]
    v_pk_mul_f32 v[120:121], v[64:65], v[78:79] op_sel_hi:[1,0]
    v_pk_mul_f32 v[122:123], v[66:67], v[78:79] op_sel_hi:[1,0]
    v_cvt_pk_bf16_f32 v126, v94, v95
    v_cvt_pk_bf16_f32 v127, v96, v97
    ds_write2_b32 v141, v126, v127 offset0:40 offset1:12
    v_pk_fma_f32 v[88:89], v[64:65], v[78:79], v[120:121] op_sel:[1,1,0] op_sel_hi:[0,1,1] neg_lo:[0,1,0]
    v_pk_fma_f32 v[90:91], v[66:67], v[78:79], v[122:123] op_sel:[1,1,0] op_sel_hi:[0,1,1] neg_lo:[0,1,0]
    v_pk_mul_f32 v[120:121], v[64:65], v[80:81] op_sel_hi:[1,0]
    v_pk_mul_f32 v[122:123], v[66:67], v[80:81] op_sel_hi:[1,0]
    v_cvt_pk_bf16_f32 v124, v98, v99
    v_cvt_pk_bf16_f32 v125, v88, v89
    ds_write2_b32 v141, v124, v125 offset0:44 offset1:16
    v_pk_fma_f32 v[92:93], v[64:65], v[80:81], v[120:121] op_sel:[1,1,0] op_sel_hi:[0,1,1] neg_lo:[0,1,0]
    v_pk_fma_f32 v[94:95], v[66:67], v[80:81], v[122:123] op_sel:[1,1,0] op_sel_hi:[0,1,1] neg_lo:[0,1,0]
    v_pk_mul_f32 v[120:121], v[64:65], v[82:83] op_sel_hi:[1,0]
    v_pk_mul_f32 v[122:123], v[66:67], v[82:83] op_sel_hi:[1,0]
    v_cvt_pk_bf16_f32 v126, v90, v91
    v_cvt_pk_bf16_f32 v127, v92, v93
    ds_write2_b32 v141, v126, v127 offset0:48 offset1:20
    v_pk_fma_f32 v[96:97], v[64:65], v[82:83], v[120:121] op_sel:[1,1,0] op_sel_hi:[0,1,1] neg_lo:[0,1,0]
    v_pk_fma_f32 v[98:99], v[66:67], v[82:83], v[122:123] op_sel:[1,1,0] op_sel_hi:[0,1,1] neg_lo:[0,1,0]
    v_pk_mul_f32 v[120:121], v[64:65], v[84:85] op_sel_hi:[1,0]
    v_pk_mul_f32 v[122:123], v[66:67], v[84:85] op_sel_hi:[1,0]
    v_cvt_pk_bf16_f32 v124, v94, v95
    v_cvt_pk_bf16_f32 v125, v96, v97
    ds_write2_b32 v141, v124, v125 offset0:52 offset1:24
    v_pk_fma_f32 v[88:89], v[64:65], v[84:85], v[120:121] op_sel:[1,1,0] op_sel_hi:[0,1,1] neg_lo:[0,1,0]
    v_pk_fma_f32 v[90:91], v[66:67], v[84:85], v[122:123] op_sel:[1,1,0] op_sel_hi:[0,1,1] neg_lo:[0,1,0]
    v_pk_mul_f32 v[120:121], v[68:69], v[86:87] op_sel_hi:[1,0]
    v_pk_mul_f32 v[122:123], v[68:69], v[74:75] op_sel_hi:[1,0]
    v_cvt_pk_bf16_f32 v126, v98, v99
    v_cvt_pk_bf16_f32 v127, v88, v89
    ds_write2_b32 v141, v126, v127 offset0:56 offset1:28
    v_pk_fma_f32 v[70:71], v[68:69], v[86:87], v[120:121] op_sel:[1,1,0] op_sel_hi:[0,1,1] neg_lo:[0,1,0]
    v_pk_fma_f32 v[92:93], v[68:69], v[74:75], v[122:123] op_sel:[1,1,0] op_sel_hi:[0,1,1] neg_lo:[0,1,0]
    v_pk_mul_f32 v[120:121], v[68:69], v[78:79] op_sel_hi:[1,0]
    v_pk_mul_f32 v[122:123], v[68:69], v[82:83] op_sel_hi:[1,0]
    v_cvt_pk_bf16_f32 v124, v90, v91
    v_cvt_pk_bf16_f32 v125, v70, v71
    ds_write2_b32 v141, v124, v125 offset0:60 offset1:80
    v_pk_fma_f32 v[94:95], v[68:69], v[78:79], v[120:121] op_sel:[1,1,0] op_sel_hi:[0,1,1] neg_lo:[0,1,0]
    v_pk_fma_f32 v[96:97], v[68:69], v[82:83], v[122:123] op_sel:[1,1,0] op_sel_hi:[0,1,1] neg_lo:[0,1,0]
    v_pk_mul_f32 v[120:121], v[70:71], v[86:87] op_sel_hi:[1,0]
    v_pk_mul_f32 v[122:123], v[70:71], v[74:75] op_sel_hi:[1,0]
    v_cvt_pk_bf16_f32 v126, v92, v93
    v_cvt_pk_bf16_f32 v127, v94, v95
    ds_write2_b32 v141, v126, v127 offset0:68 offset1:72
    v_pk_fma_f32 v[64:65], v[70:71], v[86:87], v[120:121] op_sel:[1,1,0] op_sel_hi:[0,1,1] neg_lo:[0,1,0]
    v_pk_fma_f32 v[98:99], v[70:71], v[74:75], v[122:123] op_sel:[1,1,0] op_sel_hi:[0,1,1] neg_lo:[0,1,0]
    v_pk_mul_f32 v[120:121], v[70:71], v[78:79] op_sel_hi:[1,0]
    v_pk_mul_f32 v[122:123], v[70:71], v[82:83] op_sel_hi:[1,0]
    v_cvt_pk_bf16_f32 v124, v96, v97
    v_cvt_pk_bf16_f32 v125, v64, v65
    ds_write2_b32 v141, v124, v125 offset0:76 offset1:96
    v_pk_fma_f32 v[88:89], v[70:71], v[78:79], v[120:121] op_sel:[1,1,0] op_sel_hi:[0,1,1] neg_lo:[0,1,0]
    v_pk_fma_f32 v[90:91], v[70:71], v[82:83], v[122:123] op_sel:[1,1,0] op_sel_hi:[0,1,1] neg_lo:[0,1,0]
    v_pk_mul_f32 v[120:121], v[64:65], v[86:87] op_sel_hi:[1,0]
    v_pk_mul_f32 v[122:123], v[64:65], v[78:79] op_sel_hi:[1,0]
    v_cvt_pk_bf16_f32 v126, v98, v99
    v_cvt_pk_bf16_f32 v127, v88, v89
    ds_write2_b32 v141, v126, v127 offset0:84 offset1:88
    v_pk_fma_f32 v[66:67], v[64:65], v[86:87], v[120:121] op_sel:[1,1,0] op_sel_hi:[0,1,1] neg_lo:[0,1,0]
    v_pk_fma_f32 v[92:93], v[64:65], v[78:79], v[122:123] op_sel:[1,1,0] op_sel_hi:[0,1,1] neg_lo:[0,1,0]
    v_pk_mul_f32 v[120:121], v[66:67], v[86:87] op_sel_hi:[1,0]
    v_pk_mul_f32 v[122:123], v[66:67], v[78:79] op_sel_hi:[1,0]
    v_cvt_pk_bf16_f32 v124, v90, v91
    v_cvt_pk_bf16_f32 v125, v66, v67
    ds_write2_b32 v141, v124, v125 offset0:92 offset1:104
    v_pk_fma_f32 v[68:69], v[66:67], v[86:87], v[120:121] op_sel:[1,1,0] op_sel_hi:[0,1,1] neg_lo:[0,1,0]
    v_pk_fma_f32 v[94:95], v[66:67], v[78:79], v[122:123] op_sel:[1,1,0] op_sel_hi:[0,1,1] neg_lo:[0,1,0]
    v_pk_mul_f32 v[120:121], v[68:69], v[86:87] op_sel_hi:[1,0]
    v_pk_mul_f32 v[122:123], v[68:69], v[78:79] op_sel_hi:[1,0]
    v_cvt_pk_bf16_f32 v126, v92, v93
    v_cvt_pk_bf16_f32 v127, v68, v69
    ds_write2_b32 v141, v126, v127 offset0:100 offset1:112
    v_pk_fma_f32 v[70:71], v[68:69], v[86:87], v[120:121] op_sel:[1,1,0] op_sel_hi:[0,1,1] neg_lo:[0,1,0]
    v_pk_fma_f32 v[96:97], v[68:69], v[78:79], v[122:123] op_sel:[1,1,0] op_sel_hi:[0,1,1] neg_lo:[0,1,0]
    v_pk_mul_f32 v[120:121], v[70:71], v[78:79] op_sel_hi:[1,0]
    v_cvt_pk_bf16_f32 v124, v94, v95
    v_cvt_pk_bf16_f32 v125, v70, v71
    ds_write2_b32 v141, v124, v125 offset0:108 offset1:120
    v_pk_fma_f32 v[98:99], v[70:71], v[78:79], v[120:121] op_sel:[1,1,0] op_sel_hi:[0,1,1] neg_lo:[0,1,0]
    v_cvt_pk_bf16_f32 v126, v96, v97
    v_cvt_pk_bf16_f32 v127, v98, v99
    ds_write2_b32 v141, v126, v127 offset0:116 offset1:124
    s_branch L_chaind
L_sideY:
    v_mul_f32 v117, 0xc1000000, v154
    v_mul_f32 v116, 0x41000000, v153
    v_fract_f32 v117, v117
    v_exp_f32 v116, v116
    v_cos_f32 v72, v117
    v_sin_f32 v73, v117
    s_nop 0
    v_pk_mul_f32 v[72:73], v[72:73], v[116:117] op_sel_hi:[1,0]
    v_mul_f32 v117, 0x44800000, v154
    v_mul_f32 v116, 0x44800000, v153
    v_fract_f32 v117, v117
    v_exp_f32 v116, v116
    v_cos_f32 v80, v117
    v_sin_f32 v81, v117
    s_nop 0
    v_pk_mul_f32 v[80:81], v[80:81], v[116:117] op_sel_hi:[1,0]
    v_mul_f32 v117, 0x43000000, v154
    v_mul_f32 v116, 0x43000000, v153
    v_fract_f32 v117, v117
    v_exp_f32 v116, v116
    v_cos_f32 v76, v117
    v_sin_f32 v77, v117
    s_nop 0
    v_pk_mul_f32 v[76:77], v[76:77], v[116:117] op_sel_hi:[1,0]
    v_mov_b32 v98, 1.0
    v_mov_b32 v99, 0
    v_pk_mul_f32 v[120:121], v[72:73], v[72:73] op_sel_hi:[1,0]
    v_pk_mul_f32 v[122:123], v[64:65], v[80:81] op_sel_hi:[1,0]
    v_cvt_pk_bf16_f32 v124, v98, v99
    v_cvt_pk_bf16_f32 v125, v72, v73
    ds_write2_b32 v141, v124, v125 offset0:192 offset1:196
    v_pk_fma_f32 v[74:75], v[72:73], v[72:73], v[120:121] op_sel:[1,1,0] op_sel_hi:[0,1,1] neg_lo:[0,1,0]
    v_pk_fma_f32 v[90:91], v[64:65], v[80:81], v[122:123] op_sel:[1,1,0] op_sel_hi:[0,1,1] neg_lo:[0,1,0]
    v_pk_mul_f32 v[120:121], v[76:77], v[76:77] op_sel_hi:[1,0]
    v_pk_mul_f32 v[122:123], v[72:73], v[74:75] op_sel_hi:[1,0]
    v_cvt_pk_bf16_f32 v126, v74, v75
    v_cvt_pk_bf16_f32 v127, v90, v91
    ds_write2_b32 v141, v126, v127 offset0:200 offset1:128
    v_pk_fma_f32 v[78:79], v[76:77], v[76:77], v[120:121] op_sel:[1,1,0] op_sel_hi:[0,1,1] neg_lo:[0,1,0]
    v_pk_fma_f32 v[86:87], v[72:73], v[74:75], v[122:123] op_sel:[1,1,0] op_sel_hi:[0,1,1] neg_lo:[0,1,0]
    v_pk_mul_f32 v[120:121], v[90:91], v[76:77] op_sel_hi:[1,0]
    v_pk_mul_f32 v[122:123], v[74:75], v[74:75] op_sel_hi:[1,0]
    v_pk_fma_f32 v[92:93], v[90:91], v[76:77], v[120:121] op_sel:[1,1,0] op_sel_hi:[0,1,1] neg_lo:[0,1,0]
    v_pk_fma_f32 v[88:89], v[74:75], v[74:75], v[122:123] op_sel:[1,1,0] op_sel_hi:[0,1,1] neg_lo:[0,1,0]
    v_pk_mul_f32 v[120:121], v[86:87], v[74:75] op_sel_hi:[1,0]
    v_pk_mul_f32 v[122:123], v[90:91], v[78:79] op_sel_hi:[1,0]
    v_cvt_pk_bf16_f32 v124, v86, v87
    v_cvt_pk_bf16_f32 v125, v92, v93
    ds_write2_b32 v141, v124, v125 offset0:204 offset1:132
    v_pk_fma_f32 v[84:85], v[86:87], v[74:75], v[120:121] op_sel:[1,1,0] op_sel_hi:[0,1,1] neg_lo:[0,1,0]
    v_pk_fma_f32 v[94:95], v[90:91], v[78:79], v[122:123] op_sel:[1,1,0] op_sel_hi:[0,1,1] neg_lo:[0,1,0]
    v_pk_mul_f32 v[120:121], v[88:89], v[74:75] op_sel_hi:[1,0]
    v_pk_mul_f32 v[122:123], v[92:93], v[78:79] op_sel_hi:[1,0]
    v_cvt_pk_bf16_f32 v126, v88, v89
    v_cvt_pk_bf16_f32 v127, v84, v85
    ds_write2_b32 v141, v126, v127 offset0:208 offset1:212
    v_pk_fma_f32 v[86:87], v[88:89], v[74:75], v[120:121] op_sel:[1,1,0] op_sel_hi:[0,1,1] neg_lo:[0,1,0]
    v_pk_fma_f32 v[96:97], v[92:93], v[78:79], v[122:123] op_sel:[1,1,0] op_sel_hi:[0,1,1] neg_lo:[0,1,0]
    v_pk_mul_f32 v[120:121], v[84:85], v[74:75] op_sel_hi:[1,0]
    v_pk_mul_f32 v[122:123], v[94:95], v[78:79] op_sel_hi:[1,0]
    v_cvt_pk_bf16_f32 v124, v94, v95
    v_cvt_pk_bf16_f32 v125, v86, v87
    ds_write2_b32 v141, v124, v125 offset0:136 offset1:216
    v_pk_fma_f32 v[88:89], v[84:85], v[74:75], v[120:121] op_sel:[1,1,0] op_sel_hi:[0,1,1] neg_lo:[0,1,0]
    v_pk_fma_f32 v[90:91], v[94:95], v[78:79], v[122:123] op_sel:[1,1,0] op_sel_hi:[0,1,1] neg_lo:[0,1,0]
    v_pk_mul_f32 v[120:121], v[86:87], v[74:75] op_sel_hi:[1,0]
    v_pk_mul_f32 v[122:123], v[96:97], v[78:79] op_sel_hi:[1,0]
    v_cvt_pk_bf16_f32 v126, v96, v97
    v_cvt_pk_bf16_f32 v127, v88, v89
    ds_write2_b32 v141, v126, v127 offset0:140 offset1:220
    v_pk_fma_f32 v[82:83], v[86:87], v[74:75], v[120:121] op_sel:[1,1,0] op_sel_hi:[0,1,1] neg_lo:[0,1,0]
    v_pk_fma_f32 v[92:93], v[96:97], v[78:79], v[122:123] op_sel:[1,1,0] op_sel_hi:[0,1,1] neg_lo:[0,1,0]
    v_pk_mul_f32 v[120:121], v[88:89], v[74:75] op_sel_hi:[1,0]
    v_pk_mul_f32 v[122:123], v[90:91], v[78:79] op_sel_hi:[1,0]
    v_cvt_pk_bf16_f32 v124, v90, v91
    v_cvt_pk_bf16_f32 v125, v82, v83
    ds_write2_b32 v141, v124, v125 offset0:144 offset1:224
    v_pk_fma_f32 v[84:85], v[88:89], v[74:75], v[120:121] op_sel:[1,1,0] op_sel_hi:[0,1,1] neg_lo:[0,1,0]
    v_pk_fma_f32 v[94:95], v[90:91], v[78:79], v[122:123] op_sel:[1,1,0] op_sel_hi:[0,1,1] neg_lo:[0,1,0]
    v_pk_mul_f32 v[120:121], v[82:83], v[74:75] op_sel_hi:[1,0]
    v_pk_mul_f32 v[122:123], v[92:93], v[78:79] op_sel_hi:[1,0]
    v_cvt_pk_bf16_f32 v126, v92, v93
    v_cvt_pk_bf16_f32 v127, v84, v85
    ds_write2_b32 v141, v126, v127 offset0:148 offset1:228
    v_pk_fma_f32 v[86:87], v[82:83], v[74:75], v[120:121] op_sel:[1,1,0] op_sel_hi:[0,1,1] neg_lo:[0,1,0]
    v_pk_fma_f32 v[96:97], v[92:93], v[78:79], v[122:123] op_sel:[1,1,0] op_sel_hi:[0,1,1] neg_lo:[0,1,0]
    v_pk_mul_f32 v[120:121], v[84:85], v[74:75] op_sel_hi:[1,0]
    v_pk_mul_f32 v[122:123], v[94:95], v[78:79] op_sel_hi:[1,0]
    v_cvt_pk_bf16_f32 v124, v94, v95
    v_cvt_pk_bf16_f32 v125, v86, v87
    ds_write2_b32 v141, v124, v125 offset0:152 offset1:232
    v_pk_fma_f32 v[88:89], v[84:85], v[74:75], v[120:121] op_sel:[1,1,0] op_sel_hi:[0,1,1] neg_lo:[0,1,0]
    v_pk_fma_f32 v[90:91], v[94:95], v[78:79], v[122:123] op_sel:[1,1,0] op_sel_hi:[0,1,1] neg_lo:[0,1,0]
    v_pk_mul_f32 v[120:121], v[86:87], v[74:75] op_sel_hi:[1,0]
    v_pk_mul_f32 v[122:123], v[88:89], v[74:75] op_sel_hi:[1,0]
    v_cvt_pk_bf16_f32 v126, v96, v97
    v_cvt_pk_bf16_f32 v127, v88, v89
    ds_write2_b32 v141, v126, v127 offset0:156 offset1:236
    v_pk_fma_f32 v[82:83], v[86:87], v[74:75], v[120:121] op_sel:[1,1,0] op_sel_hi:[0,1,1] neg_lo:[0,1,0]
    v_pk_fma_f32 v[84:85], v[88:89], v[74:75], v[122:123] op_sel:[1,1,0] op_sel_hi:[0,1,1] neg_lo:[0,1,0]
    v_pk_mul_f32 v[120:121], v[82:83], v[74:75] op_sel_hi:[1,0]
    v_pk_mul_f32 v[122:123], v[84:85], v[74:75] op_sel_hi:[1,0]
    v_cvt_pk_bf16_f32 v124, v90, v91
    v_cvt_pk_bf16_f32 v125, v82, v83
    ds_write2_b32 v141, v124, v125 offset0:160 offset1:240
    v_pk_fma_f32 v[86:87], v[82:83], v[74:75], v[120:121] op_sel:[1,1,0] op_sel_hi:[0,1,1] neg_lo:[0,1,0]
    v_pk_fma_f32 v[88:89], v[84:85], v[74:75], v[122:123] op_sel:[1,1,0] op_sel_hi:[0,1,1] neg_lo:[0,1,0]
    v_cvt_pk_bf16_f32 v126, v84, v85
    v_cvt_pk_bf16_f32 v127, v86, v87
    ds_write2_b32 v141, v126, v127 offset0:244 offset1:248
    v_cvt_pk_bf16_f32 v124, v88, v89
    ds_write_b32 v141, v124 offset:1008
L_chaind:
    s_waitcnt lgkmcnt(0)
    s_barrier
    s_cmp_ge_u32 s4, 4
    s_cbranch_scc1 L_noband
    s_add_u32 s6, s12, L_band-L_pc
    s_addc_u32 s7, s13, 0
    global_load_dwordx4 v[154:157], v2, s[6:7]
    global_load_dwordx4 v[158:161], v2, s[6:7] offset:1024
L_noband:
    s_sub_u32 s67, s46, 2097152
    buffer_store_dwordx4 v[44:47], v151, s[8:11], s67 offen sc1
    s_and_b32 s6, s4, 3
    s_cmp_eq_u32 s6, 3
    s_cbranch_scc1 L_nokm
    ds_read_b128 v[168:171], v142 offset:0
    ds_read_b128 v[172:175], v143 offset:0
    ds_read_b128 v[176:179], v142 offset:4160
    ds_read_b128 v[180:183], v143 offset:4160
    ds_read_b128 v[184:187], v142 offset:8320
    ds_read_b128 v[188:191], v143 offset:8320
    ds_read_b128 v[192:195], v142 offset:12480
    ds_read_b128 v[196:199], v143 offset:12480
    ds_read_b128 v[200:203], v142 offset:16640
    ds_read_b128 v[204:207], v143 offset:16640
    ds_read_b128 v[208:211], v142 offset:20800
    ds_read_b128 v[212:215], v143 offset:20800
    ds_read_b128 v[216:219], v142 offset:24960
    ds_read_b128 v[220:223], v143 offset:24960
    ds_read_b128 v[224:227], v142 offset:29120
    ds_read_b128 v[228:231], v143 offset:29120
    s_waitcnt lgkmcnt(14)
    v_mfma_f32_16x16x32_bf16 v[232:235], v[168:171], v[172:175], 0
    s_waitcnt lgkmcnt(12)
    v_mfma_f32_16x16x32_bf16 v[232:235], v[176:179], v[180:183], v[232:235]
    s_waitcnt lgkmcnt(10)
    v_mfma_f32_16x16x32_bf16 v[232:235], v[184:187], v[188:191], v[232:235]
    s_waitcnt lgkmcnt(8)
    v_mfma_f32_16x16x32_bf16 v[232:235], v[192:195], v[196:199], v[232:235]
    s_waitcnt lgkmcnt(6)
    v_mfma_f32_16x16x32_bf16 v[232:235], v[200:203], v[204:207], v[232:235]
    s_waitcnt lgkmcnt(4)
    v_mfma_f32_16x16x32_bf16 v[232:235], v[208:211], v[212:215], v[232:235]
    s_waitcnt lgkmcnt(2)
    v_mfma_f32_16x16x32_bf16 v[232:235], v[216:219], v[220:223], v[232:235]
    s_waitcnt lgkmcnt(0)
    v_mfma_f32_16x16x32_bf16 v[232:235], v[224:227], v[228:231], v[232:235]
    s_nop 7
L_nokm:
    v_mov_b32 v184, 0
    v_mov_b32 v185, 0
    v_mov_b32 v186, 0
    v_mov_b32 v187, 0
    s_cmp_ge_u32 s6, 2
    s_cbranch_scc1 L_tf
    ds_write_b64 v144, v[232:233]
    ds_write_b64 v131, v[234:235]
    s_branch L_notf
L_tf:
    s_cmp_eq_u32 s6, 3
    s_cbranch_scc1 L_notf
    s_lshr_b32 s66, s4, 2
    s_mul_i32 s66, s66, 3328
    s_add_u32 s66, s66, 49152
    v_mov_b32 v236, s66
    s_mov_b64 exec, 1
    ds_write_b32 v236, v232
    v_mov_b32 v232, 0
    s_mov_b64 exec, -1
    v_cvt_pk_bf16_f32 v236, v232, v232
    v_cvt_pk_bf16_f32 v237, v233, v233
    v_cvt_pk_bf16_f32 v238, v234, v234
    v_cvt_pk_bf16_f32 v239, v235, v235
    s_mov_b32 exec_hi, 1
    ds_write_b16 v128, v236 offset:48
    ds_write_b16 v128, v236 offset:446
    ds_write_b16 v128, v236 offset:844
    ds_write_b16 v128, v236 offset:1242
    s_mov_b32 exec_hi, 0
    ds_write_b16 v128, v237 offset:32
    ds_write_b16 v128, v237 offset:430
    ds_write_b16 v128, v237 offset:828
    ds_write_b16 v128, v237 offset:1226
    ds_write_b16 v128, v238 offset:16
    ds_write_b16 v128, v238 offset:414
    ds_write_b16 v128, v238 offset:812
    ds_write_b16 v128, v238 offset:1210
    ds_write_b16 v128, v239 offset:0
    ds_write_b16 v128, v239 offset:398
    ds_write_b16 v128, v239 offset:796
    ds_write_b16 v128, v239 offset:1194
    s_mov_b64 exec, -1
L_notf:
    s_waitcnt lgkmcnt(0)
    s_barrier
    buffer_load_dwordx4 v[48:51], v102, s[8:11], s77 offen sc1
    buffer_load_dwordx4 v[52:55], v102, s[8:11], s77 offen offset:16 sc1
    s_cmp_eq_u32 s6, 1
    s_cbranch_scc1 L_x1
    s_cmp_eq_u32 s6, 2
    s_cbranch_scc1 L_x2
    ds_write_b128 v146, v[184:187]
    s_cmp_eq_u32 s6, 3
    s_cbranch_scc1 L_xd2
    ds_read_b64 v[168:169], v147
    ds_read_b32 v170, v147 offset:8
    s_waitcnt lgkmcnt(0)
    v_cvt_pk_bf16_f32 v176, v170, v170
    v_cvt_pk_bf16_f32 v177, v169, v169
    v_cvt_pk_bf16_f32 v178, v169, v168
    v_cvt_pk_bf16_f32 v179, v168, v168
    s_branch L_xd
L_x1:
    ds_read_b128 v[168:171], v147
    ds_read_b128 v[172:175], v147 offset:16
    ds_write_b128 v146, v[184:187]
    s_waitcnt lgkmcnt(1)
    v_cvt_pk_bf16_f32 v176, v175, v174
    v_cvt_pk_bf16_f32 v177, v173, v172
    v_cvt_pk_bf16_f32 v178, v171, v170
    v_cvt_pk_bf16_f32 v179, v169, v168
    s_mov_b32 exec_hi, 0
    v_cvt_pk_bf16_f32 v176, v172, v171
    v_cvt_pk_bf16_f32 v177, v170, v170
    v_cvt_pk_bf16_f32 v178, v170, v169
    v_cvt_pk_bf16_f32 v179, v168, v168
    s_mov_b64 exec, -1
    s_branch L_xd
L_x2:
    s_lshr_b32 s66, s4, 2
    s_mul_i32 s67, s66, 3328
    s_add_u32 s67, s67, 49152
    v_mov_b32 v169, s67
    ds_read_b32 v168, v169
    s_mul_i32 s67, s66, 17920
    s_add_u32 s67, s67, 57024
    v_and_b32 v170, 16, v151
    v_add_u32 v170, s67, v170
    v_mov_b32 v176, 0
    s_waitcnt lgkmcnt(0)
    v_cndmask_b32_e64 v168, v168, 0, s[78:79]
    v_cvt_pk_bf16_f32 v177, 0, v168
    v_cvt_pk_bf16_f32 v178, v168, v168
    v_cvt_pk_bf16_f32 v179, v168, v168
    ds_write_b128 v170, v[176:179]
    s_branch L_xd2
L_xd:
    ds_write_b128 v145, v[176:179]
L_xd2:
    s_waitcnt lgkmcnt(0)
    s_barrier
    ds_read_b128 v[176:179], v145
    ds_read_b128 v[180:183], v145 offset:16
    s_cmp_lt_u32 s4, 4
    s_cbranch_scc1 L_nowl
    global_load_ushort v212, v148, s[32:33] offset:0
    global_load_short_d16_hi v216, v148, s[34:35] offset:0
    global_load_ushort v213, v148, s[32:33] offset:514
    global_load_short_d16_hi v217, v148, s[34:35] offset:514
    global_load_ushort v214, v148, s[32:33] offset:1028
    global_load_short_d16_hi v218, v148, s[34:35] offset:1028
    global_load_ushort v215, v148, s[32:33] offset:1542
    global_load_short_d16_hi v219, v148, s[34:35] offset:1542
    global_load_ushort v220, v149, s[32:33] offset:0
    global_load_short_d16_hi v224, v149, s[34:35] offset:0
    global_load_ushort v221, v149, s[32:33] offset:514
    global_load_short_d16_hi v225, v149, s[34:35] offset:514
    global_load_ushort v222, v149, s[32:33] offset:1028
    global_load_short_d16_hi v226, v149, s[34:35] offset:1028
    global_load_ushort v223, v149, s[32:33] offset:1542
    global_load_short_d16_hi v227, v149, s[34:35] offset:1542
L_nowl:
    s_cmp_ge_u32 s6, 2
    s_cbranch_scc1 L_y2
    s_waitcnt lgkmcnt(0)
    ds_write_b128 v145, v[178:181] offset:8960
    v_alignbit_b32 v196, v177, v176, 16
    v_alignbit_b32 v197, v178, v177, 16
    v_alignbit_b32 v198, v179, v178, 16
    v_alignbit_b32 v199, v180, v179, 16
    ds_write_b128 v145, v[196:199] offset:2240
    v_mov_b32 v188, v177
    v_mov_b32 v189, v178
    v_mov_b32 v190, v179
    v_mov_b32 v191, v180
    ds_write_b128 v145, v[188:191] offset:4480
    v_alignbit_b32 v204, v178, v177, 16
    v_alignbit_b32 v205, v179, v178, 16
    v_alignbit_b32 v206, v180, v179, 16
    v_alignbit_b32 v207, v181, v180, 16
    ds_write_b128 v145, v[204:207] offset:6720
    s_branch L_yd
L_y2:
    s_cmp_eq_u32 s6, 2
    s_cbranch_scc1 L_y3
    s_mov_b64 exec, 0xffff
    ds_read_b128 v[168:171], v129
    s_waitcnt lgkmcnt(0)
    ds_write_b128 v130, v[168:171]
    s_mov_b64 exec, -1
L_y3:
    s_waitcnt lgkmcnt(0)
    v_alignbit_b32 v196, v179, v178, 16
    v_alignbit_b32 v197, v180, v179, 16
    v_alignbit_b32 v198, v181, v180, 16
    v_alignbit_b32 v199, v182, v181, 16
    ds_write_b128 v145, v[196:199] offset:11200
    v_mov_b32 v188, v179
    v_mov_b32 v189, v180
    v_mov_b32 v190, v181
    v_mov_b32 v191, v182
    ds_write_b128 v145, v[188:191] offset:13440
    v_alignbit_b32 v204, v180, v179, 16
    v_alignbit_b32 v205, v181, v180, 16
    v_alignbit_b32 v206, v182, v181, 16
    v_alignbit_b32 v207, v183, v182, 16
    ds_write_b128 v145, v[204:207] offset:15680
L_yd:
    s_cmp_lt_u32 s4, 4
    s_cbranch_scc1 L_e0w
    s_waitcnt vmcnt(16)
    s_branch L_e0w2
L_e0w:
    s_waitcnt vmcnt(0)
L_e0w2:
    s_mov_b32 s15, 1000000
    s_branch L_e0chk
L_e0:
    buffer_load_dwordx4 v[48:51], v102, s[8:11], s77 offen sc1
    buffer_load_dwordx4 v[52:55], v102, s[8:11], s77 offen offset:16 sc1
    s_waitcnt vmcnt(0)
L_e0chk:
    v_cmp_ne_u32 vcc, s42, v50
    v_cmp_ne_u32_e64 s[48:49], s43, v51
    v_cmp_ne_u32_e64 s[50:51], s42, v54
    v_cmp_ne_u32_e64 s[52:53], s43, v55
    s_or_b64 vcc, vcc, s[48:49]
    s_or_b64 s[50:51], s[50:51], s[52:53]
    s_or_b64 exec, vcc, s[50:51]
    s_cbranch_scc0 L_e0d
    s_sub_u32 s15, s15, 1
    s_cbranch_scc0 L_e0
    s_mov_b64 exec, -1
    v_mov_b32 v103, 64
    global_store_dword v103, v103, s[38:39]
L_e0d:
    s_mov_b64 exec, -1
    v_mov_b32 v50, v52
    v_mov_b32 v51, v53
L_conv_in:
    v_mov_b32_dpp v112, v48 quad_perm:[2,3,0,1] row_mask:0xf bank_mask:0xf
    v_mov_b32_dpp v113, v49 quad_perm:[2,3,0,1] row_mask:0xf bank_mask:0xf
    v_mov_b32_dpp v114, v50 quad_perm:[2,3,0,1] row_mask:0xf bank_mask:0xf
    v_mov_b32_dpp v115, v51 quad_perm:[2,3,0,1] row_mask:0xf bank_mask:0xf
    v_perm_b32 v112, v112, v48, v19
    ds_write_b32 v4, v112 offset:0
    v_perm_b32 v113, v113, v49, v19
    ds_write_b32 v4, v113 offset:128
    v_perm_b32 v114, v114, v50, v19
    ds_write_b32 v4, v114 offset:256
    v_perm_b32 v115, v115, v51, v19
    ds_write_b32 v4, v115 offset:384
    global_load_short_d16_hi v28, v166, s[28:29] offset:0
    global_load_short_d16_hi v29, v166, s[28:29] offset:32
    global_load_short_d16_hi v30, v166, s[28:29] offset:64
    global_load_short_d16_hi v31, v166, s[28:29] offset:96
    global_load_short_d16_hi v32, v166, s[28:29] offset:512
    global_load_short_d16_hi v33, v166, s[28:29] offset:544
    global_load_short_d16_hi v34, v166, s[28:29] offset:576
    global_load_short_d16_hi v35, v166, s[28:29] offset:608
L_it1w:
    s_waitcnt lgkmcnt(0)
    s_cmp_ge_u32 s4, 4
    s_cbranch_scc1 L_ca1
    s_cmp_eq_u32 s5, 0
    s_cbranch_scc1 L_ca1
    ds_read_b128 v[168:171], v5 offset:2048
    ds_read_b128 v[172:175], v5 offset:1024
    ds_read_b128 v[104:107], v5 offset:0
L_ca1:
    s_barrier
    s_cmp_lt_u32 s4, 4
    s_cbranch_scc1 L_conv
    s_cmp_lg_u32 s5, 0
    s_cbranch_scc1 L_help2
    s_sub_u32 s69, s4, 4
    s_add_u32 s66, s69, 0
    s_min_u32 s66, s66, 21
    s_lshl_b32 s66, s66, 10
    s_add_u32 s6, s12, L_table-L_pc
    s_addc_u32 s7, s13, 0
    s_mov_b32 m0, s66
    s_add_u32 s6, s6, s66
    s_addc_u32 s7, s7, 0
    global_load_lds_dwordx4 v2, s[6:7]
    s_add_u32 s66, s69, 4
    s_min_u32 s66, s66, 21
    s_lshl_b32 s66, s66, 10
    s_add_u32 s6, s12, L_table-L_pc
    s_addc_u32 s7, s13, 0
    s_mov_b32 m0, s66
    s_add_u32 s6, s6, s66
    s_addc_u32 s7, s7, 0
    global_load_lds_dwordx4 v2, s[6:7]
    s_add_u32 s66, s69, 8
    s_min_u32 s66, s66, 21
    s_lshl_b32 s66, s66, 10
    s_add_u32 s6, s12, L_table-L_pc
    s_addc_u32 s7, s13, 0
    s_mov_b32 m0, s66
    s_add_u32 s6, s6, s66
    s_addc_u32 s7, s7, 0
    global_load_lds_dwordx4 v2, s[6:7]
    s_add_u32 s66, s69, 12
    s_min_u32 s66, s66, 21
    s_lshl_b32 s66, s66, 10
    s_add_u32 s6, s12, L_table-L_pc
    s_addc_u32 s7, s13, 0
    s_mov_b32 m0, s66
    s_add_u32 s6, s6, s66
    s_addc_u32 s7, s7, 0
    global_load_lds_dwordx4 v2, s[6:7]
    s_add_u32 s66, s69, 16
    s_min_u32 s66, s66, 21
    s_lshl_b32 s66, s66, 10
    s_add_u32 s6, s12, L_table-L_pc
    s_addc_u32 s7, s13, 0
    s_mov_b32 m0, s66
    s_add_u32 s6, s6, s66
    s_addc_u32 s7, s7, 0
    global_load_lds_dwordx4 v2, s[6:7]
    s_add_u32 s66, s69, 20
    s_min_u32 s66, s66, 21
    s_lshl_b32 s66, s66, 10
    s_add_u32 s6, s12, L_table-L_pc
    s_addc_u32 s7, s13, 0
    s_mov_b32 m0, s66
    s_add_u32 s6, s6, s66
    s_addc_u32 s7, s7, 0
    global_load_lds_dwordx4 v2, s[6:7]
    s_waitcnt vmcnt(22)
    v_or_b32 v212, v212, v216
    v_or_b32 v213, v213, v217
    v_or_b32 v214, v214, v218
    v_or_b32 v215, v215, v219
    ds_write_b128 v16, v[212:215] offset:30720
    ds_read_b128 v[212:215], v150 offset:30720
    s_waitcnt lgkmcnt(0)
    s_sub_u32 s66, s56, 4096
    buffer_store_dwordx4 v[212:215], v151, s[8:11], s66 offen sc1
    s_waitcnt vmcnt(15)
    v_or_b32 v220, v220, v224
    v_or_b32 v221, v221, v225
    v_or_b32 v222, v222, v226
    v_or_b32 v223, v223, v227
    ds_write_b128 v16, v[220:223] offset:30720
    ds_read_b128 v[220:223], v150 offset:30720
    s_waitcnt lgkmcnt(0)
    buffer_store_dwordx4 v[220:223], v151, s[8:11], s56 offen sc1
    s_sub_u32 s67, s46, 4096
    buffer_store_dwordx4 v[44:47], v151, s[8:11], s67 offen sc1
    buffer_store_dwordx4 v[44:47], v151, s[8:11], s46 offen sc1
    v_and_b32 v112, 63, v0
    v_and_b32 v115, 1, v0
    v_lshrrev_b32 v116, 5, v112
    v_lshlrev_b32 v121, 4, v115
    v_lshrrev_b32 v117, 1, v0
    v_lshl_add_u32 v11, v117, 6, v121
    v_and_b32 v117, 31, v112
    s_lshl_b32 s6, s4, 5
    v_add_u32 v117, s6, v117
    v_lshlrev_b32 v118, 4, v116
    v_lshl_add_u32 v13, v117, 6, v118
    v_and_b32 v119, 1, v117
    v_lshl_add_u32 v118, v119, 5, v118
    v_lshrrev_b32 v119, 1, v117
    v_lshl_add_u32 v9, v119, 14, v118
    v_mul_u32_u24 v118, 4160, v116
    v_lshlrev_b32 v117, 2, v117
    v_xor_b32 v14, v117, v118
    v_bfe_u32 v117, v112, 2, 2
    v_bfe_u32 v118, v112, 1, 1
    v_lshrrev_b32 v119, 4, v112
    v_lshl_add_u32 v118, v119, 1, v118
    s_and_b32 s6, s4, 1
    s_lshl_b32 s6, s6, 3
    v_add_u32 v118, s6, v118
    s_lshr_b32 s7, s4, 1
    s_lshl_b32 s7, s7, 6
    v_lshl_add_u32 v119, v117, 4, v118
    v_add_u32 v119, s7, v119
    v_lshl_add_u32 v12, v119, 6, v121
    v_lshl_add_u32 v149, v119, 13, v121
    v_lshrrev_b32 v119, 1, v119
    v_lshlrev_b32 v120, 4, v112
    v_and_b32 v120, 48, v120
    v_lshl_add_u32 v10, v119, 14, v120
    v_lshl_add_u32 v119, v118, 2, v117
    v_add_u32 v119, s7, v119
    v_mul_u32_u24 v118, 4160, v115
    v_lshlrev_b32 v119, 2, v119
    v_xor_b32 v15, v119, v118
    v_bfe_u32 v117, v112, 2, 1
    v_bfe_u32 v118, v112, 3, 1
    v_lshlrev_b32 v117, 2, v117
    v_lshl_add_u32 v117, v118, 1, v117
    v_bfe_u32 v118, v112, 1, 1
    v_add_u32 v117, v117, v118
    v_cvt_f32_u32 v118, v115
    v_mul_f32 v121, 0xbe800000, v118
    v_lshl_add_u32 v118, v116, 10, s3
    v_mul_u32_u24 v118, v117, v118
    v_lshlrev_b32 v119, 8, v117
    v_cvt_f32_u32 v118, v118
    v_cvt_f32_u32 v119, v119
    s_mov_b32 s66, 0xba000000
    v_fma_f32 v122, v118, s66, v121
    v_mul_f32 v123, s66, v119
    v_cos_f32 v118, v122
    v_sin_f32 v119, v122
    s_nop 0
    v_cvt_pk_bf16_f32 v36, v118, -v119
    v_add_f32 v122, v122, v123
    v_cos_f32 v118, v122
    v_sin_f32 v119, v122
    s_nop 0
    v_cvt_pk_bf16_f32 v37, v118, -v119
    v_add_f32 v122, v122, v123
    v_cos_f32 v118, v122
    v_sin_f32 v119, v122
    s_nop 0
    v_cvt_pk_bf16_f32 v38, v118, -v119
    v_add_f32 v122, v122, v123
    v_cos_f32 v118, v122
    v_sin_f32 v119, v122
    s_nop 0
    v_cvt_pk_bf16_f32 v39, v118, -v119
    v_lshl_add_u32 v117, v117, 8, s3
    v_lshlrev_b32 v118, 2, v116
    v_mul_u32_u24 v118, v117, v118
    v_cvt_f32_u32 v118, v118
    v_cvt_f32_u32 v119, v117
    s_mov_b32 s66, 0x3a000000
    v_fma_f32 v122, v118, s66, v121
    v_mul_f32 v123, s66, v119
    v_cos_f32 v118, v122
    v_sin_f32 v119, v122
    s_nop 0
    v_cvt_pk_bf16_f32 v40, v118, -v119
    v_add_f32 v122, v122, v123
    v_cos_f32 v118, v122
    v_sin_f32 v119, v122
    s_nop 0
    v_cvt_pk_bf16_f32 v41, v118, -v119
    v_add_f32 v122, v122, v123
    v_cos_f32 v118, v122
    v_sin_f32 v119, v122
    s_nop 0
    v_cvt_pk_bf16_f32 v42, v118, -v119
    v_add_f32 v122, v122, v123
    v_cos_f32 v118, v122
    v_sin_f32 v119, v122
    s_nop 0
    v_cvt_pk_bf16_f32 v43, v118, -v119
    s_branch L_conv_out
L_help2:
    s_sub_u32 s67, s46, 4096
    buffer_store_dwordx4 v[44:47], v151, s[8:11], s67 offen sc1
    buffer_store_dwordx4 v[44:47], v151, s[8:11], s46 offen sc1
    s_branch L_conv_out
L_conv:
    s_cmp_eq_u32 s5, 1
    s_cbranch_scc1 L_ca0
    ds_read_b128 v[168:171], v5 offset:2048
    ds_read_b128 v[172:175], v5 offset:1024
    ds_read_b128 v[104:107], v5 offset:0
L_ca0:
    ds_read_b128 v[176:179], v6 offset:240
    ds_read_b128 v[180:183], v6 offset:496
    ds_read_b128 v[184:187], v6 offset:752
    ds_read_b128 v[188:191], v6 offset:1008
    s_waitcnt lgkmcnt(2)
    v_mfma_f32_16x16x32_bf16 v[232:235], v[168:171], v[176:179], 0
    ds_read_b128 v[192:195], v5 offset:1984
    v_mfma_f32_16x16x32_bf16 v[236:239], v[168:171], v[180:183], 0
    ds_read_b128 v[200:203], v6 offset:224
    s_waitcnt lgkmcnt(2)
    v_mfma_f32_16x16x32_bf16 v[240:243], v[168:171], v[184:187], 0
    ds_read_b128 v[204:207], v6 offset:480
    v_mfma_f32_16x16x32_bf16 v[244:247], v[168:171], v[188:191], 0
    ds_read_b128 v[208:211], v6 offset:736
    v_mfma_f32_16x16x32_bf16 v[236:239], v[172:175], v[176:179], v[236:239]
    ds_read_b128 v[212:215], v6 offset:992
    v_mfma_f32_16x16x32_bf16 v[240:243], v[172:175], v[180:183], v[240:243]
    ds_read_b128 v[196:199], v5 offset:960
    v_mfma_f32_16x16x32_bf16 v[244:247], v[172:175], v[184:187], v[244:247]
    ds_read_b64 v[64:65], v162 offset:0
    ds_read_b64 v[66:67], v163 offset:0
    v_mfma_f32_16x16x32_bf16 v[240:243], v[104:107], v[176:179], v[240:243]
    v_mfma_f32_16x16x32_bf16 v[244:247], v[104:107], v[180:183], v[244:247]
    s_waitcnt lgkmcnt(5)
    v_mfma_f32_16x16x32_bf16 v[232:235], v[192:195], v[200:203], v[232:235]
    ds_read_b128 v[168:171], v5 offset:1920
    v_mfma_f32_16x16x32_bf16 v[236:239], v[192:195], v[204:207], v[236:239]
    ds_read_b128 v[176:179], v6 offset:208
    s_waitcnt lgkmcnt(5)
    v_mfma_f32_16x16x32_bf16 v[240:243], v[192:195], v[208:211], v[240:243]
    ds_read_b128 v[180:183], v6 offset:464
    v_mfma_f32_16x16x32_bf16 v[244:247], v[192:195], v[212:215], v[244:247]
    ds_read_b128 v[184:187], v6 offset:720
    s_waitcnt lgkmcnt(6)
    v_mfma_f32_16x16x32_bf16 v[236:239], v[196:199], v[200:203], v[236:239]
    ds_read_b128 v[188:191], v6 offset:976
    v_mfma_f32_16x16x32_bf16 v[240:243], v[196:199], v[204:207], v[240:243]
    ds_read_b128 v[172:175], v5 offset:896
    v_mfma_f32_16x16x32_bf16 v[244:247], v[196:199], v[208:211], v[244:247]
    ds_read_b64 v[68:69], v162 offset:128
    ds_read_b64 v[70:71], v163 offset:128
    s_waitcnt lgkmcnt(5)
    v_mfma_f32_16x16x32_bf16 v[232:235], v[168:171], v[176:179], v[232:235]
    ds_read_b128 v[192:195], v5 offset:1856
    v_mfma_f32_16x16x32_bf16 v[236:239], v[168:171], v[180:183], v[236:239]
    ds_read_b128 v[200:203], v6 offset:192
    s_waitcnt lgkmcnt(5)
    v_mfma_f32_16x16x32_bf16 v[240:243], v[168:171], v[184:187], v[240:243]
    ds_read_b128 v[204:207], v6 offset:448
    v_mfma_f32_16x16x32_bf16 v[244:247], v[168:171], v[188:191], v[244:247]
    ds_read_b128 v[208:211], v6 offset:704
    v_mfma_f32_16x16x32_bf16 v[80:83], v[64:67], v[154:157], 0
    v_mfma_f32_16x16x32_bf16 v[96:99], v[64:67], v[158:161], 0
    s_waitcnt lgkmcnt(6)
    v_mfma_f32_16x16x32_bf16 v[236:239], v[172:175], v[176:179], v[236:239]
    ds_read_b128 v[212:215], v6 offset:960
    v_mfma_f32_16x16x32_bf16 v[240:243], v[172:175], v[180:183], v[240:243]
    ds_read_b128 v[196:199], v5 offset:832
    v_mfma_f32_16x16x32_bf16 v[244:247], v[172:175], v[184:187], v[244:247]
    ds_read_b64 v[72:73], v162 offset:256
    ds_read_b64 v[74:75], v163 offset:256
    s_waitcnt lgkmcnt(5)
    v_mfma_f32_16x16x32_bf16 v[232:235], v[192:195], v[200:203], v[232:235]
    ds_read_b128 v[168:171], v5 offset:1792
    v_mfma_f32_16x16x32_bf16 v[236:239], v[192:195], v[204:207], v[236:239]
    ds_read_b128 v[176:179], v6 offset:176
    v_cvt_pk_bf16_f32 v116, v80, v81
    v_cvt_pk_bf16_f32 v117, v82, v83
    s_waitcnt lgkmcnt(5)
    v_mfma_f32_16x16x32_bf16 v[240:243], v[192:195], v[208:211], v[240:243]
    ds_read_b128 v[180:183], v6 offset:432
    v_mfma_f32_16x16x32_bf16 v[244:247], v[192:195], v[212:215], v[244:247]
    ds_read_b128 v[184:187], v6 offset:688
    v_mfma_f32_16x16x32_bf16 v[84:87], v[68:71], v[154:157], 0
    v_mfma_f32_16x16x32_bf16 v[100:103], v[68:71], v[158:161], 0
    s_waitcnt lgkmcnt(6)
    v_mfma_f32_16x16x32_bf16 v[236:239], v[196:199], v[200:203], v[236:239]
    ds_read_b128 v[188:191], v6 offset:944
    v_cvt_pk_bf16_f32 v124, v96, v97
    v_cvt_pk_bf16_f32 v125, v98, v99
    v_mfma_f32_16x16x32_bf16 v[240:243], v[196:199], v[204:207], v[240:243]
    ds_read_b128 v[172:175], v5 offset:768
    v_mfma_f32_16x16x32_bf16 v[244:247], v[196:199], v[208:211], v[244:247]
    ds_read_b64 v[76:77], v162 offset:384
    ds_read_b64 v[78:79], v163 offset:384
    s_waitcnt lgkmcnt(5)
    v_mfma_f32_16x16x32_bf16 v[232:235], v[168:171], v[176:179], v[232:235]
    ds_read_b128 v[192:195], v5 offset:1728
    v_mfma_f32_16x16x32_bf16 v[236:239], v[168:171], v[180:183], v[236:239]
    ds_read_b128 v[200:203], v6 offset:160
    v_cvt_pk_bf16_f32 v118, v84, v85
    v_cvt_pk_bf16_f32 v119, v86, v87
    s_waitcnt lgkmcnt(5)
    v_mfma_f32_16x16x32_bf16 v[240:243], v[168:171], v[184:187], v[240:243]
    ds_read_b128 v[204:207], v6 offset:416
    v_mfma_f32_16x16x32_bf16 v[244:247], v[168:171], v[188:191], v[244:247]
    ds_read_b128 v[208:211], v6 offset:672
    v_mfma_f32_16x16x32_bf16 v[88:91], v[72:75], v[154:157], 0
    v_mfma_f32_16x16x32_bf16 v[108:111], v[72:75], v[158:161], 0
    s_waitcnt lgkmcnt(6)
    v_mfma_f32_16x16x32_bf16 v[236:239], v[172:175], v[176:179], v[236:239]
    ds_read_b128 v[212:215], v6 offset:928
    v_cvt_pk_bf16_f32 v126, v100, v101
    v_cvt_pk_bf16_f32 v127, v102, v103
    v_mfma_f32_16x16x32_bf16 v[240:243], v[172:175], v[180:183], v[240:243]
    ds_read_b128 v[196:199], v5 offset:704
    v_mfma_f32_16x16x32_bf16 v[244:247], v[172:175], v[184:187], v[244:247]
    ds_read_b64 v[216:217], v164 offset:64
    ds_read_b64 v[218:219], v164 offset:96
    s_waitcnt lgkmcnt(5)
    v_mfma_f32_16x16x32_bf16 v[232:235], v[192:195], v[200:203], v[232:235]
    ds_read_b128 v[168:171], v5 offset:1664
    v_mfma_f32_16x16x32_bf16 v[236:239], v[192:195], v[204:207], v[236:239]
    ds_read_b128 v[176:179], v6 offset:144
    v_cvt_pk_bf16_f32 v120, v88, v89
    v_cvt_pk_bf16_f32 v121, v90, v91
    s_waitcnt lgkmcnt(5)
    v_mfma_f32_16x16x32_bf16 v[240:243], v[192:195], v[208:211], v[240:243]
    ds_read_b128 v[180:183], v6 offset:400
    v_mfma_f32_16x16x32_bf16 v[244:247], v[192:195], v[212:215], v[244:247]
    ds_read_b128 v[184:187], v6 offset:656
    v_mfma_f32_16x16x32_bf16 v[92:95], v[76:79], v[154:157], 0
    v_mfma_f32_16x16x32_bf16 v[112:115], v[76:79], v[158:161], 0
    s_waitcnt lgkmcnt(6)
    v_mfma_f32_16x16x32_bf16 v[236:239], v[196:199], v[200:203], v[236:239]
    ds_read_b128 v[188:191], v6 offset:912
    v_cvt_pk_bf16_f32 v128, v108, v109
    v_cvt_pk_bf16_f32 v129, v110, v111
    v_mfma_f32_16x16x32_bf16 v[240:243], v[196:199], v[204:207], v[240:243]
    ds_read_b128 v[172:175], v5 offset:640
    v_mfma_f32_16x16x32_bf16 v[244:247], v[196:199], v[208:211], v[244:247]
    ds_read_b64 v[220:221], v164 offset:264
    ds_read_b64 v[222:223], v164 offset:296
    s_waitcnt lgkmcnt(5)
    v_mfma_f32_16x16x32_bf16 v[232:235], v[168:171], v[176:179], v[232:235]
    ds_read_b128 v[192:195], v5 offset:1600
    v_mfma_f32_16x16x32_bf16 v[236:239], v[168:171], v[180:183], v[236:239]
    ds_read_b128 v[200:203], v6 offset:128
    v_cvt_pk_bf16_f32 v122, v92, v93
    v_cvt_pk_bf16_f32 v123, v94, v95
    s_waitcnt lgkmcnt(5)
    v_mfma_f32_16x16x32_bf16 v[240:243], v[168:171], v[184:187], v[240:243]
    ds_read_b128 v[204:207], v6 offset:384
    v_mfma_f32_16x16x32_bf16 v[244:247], v[168:171], v[188:191], v[244:247]
    ds_read_b128 v[208:211], v6 offset:640
    s_waitcnt lgkmcnt(6)
    v_mfma_f32_16x16x32_bf16 v[236:239], v[172:175], v[176:179], v[236:239]
    ds_read_b128 v[212:215], v6 offset:896
    v_cvt_pk_bf16_f32 v130, v112, v113
    v_cvt_pk_bf16_f32 v131, v114, v115
    v_mfma_f32_16x16x32_bf16 v[240:243], v[172:175], v[180:183], v[240:243]
    ds_read_b128 v[196:199], v5 offset:576
    v_mfma_f32_16x16x32_bf16 v[244:247], v[172:175], v[184:187], v[244:247]
    ds_read_b64 v[224:225], v164 offset:0
    ds_read_b64 v[226:227], v164 offset:32
    s_waitcnt lgkmcnt(5)
    v_mfma_f32_16x16x32_bf16 v[232:235], v[192:195], v[200:203], v[232:235]
    ds_read_b128 v[168:171], v5 offset:1536
    v_mfma_f32_16x16x32_bf16 v[236:239], v[192:195], v[204:207], v[236:239]
    ds_read_b128 v[176:179], v6 offset:112
    s_waitcnt lgkmcnt(5)
    v_mfma_f32_16x16x32_bf16 v[240:243], v[192:195], v[208:211], v[240:243]
    ds_read_b128 v[180:183], v6 offset:368
    v_mfma_f32_16x16x32_bf16 v[244:247], v[192:195], v[212:215], v[244:247]
    ds_read_b128 v[184:187], v6 offset:624
    s_waitcnt lgkmcnt(6)
    v_mfma_f32_16x16x32_bf16 v[236:239], v[196:199], v[200:203], v[236:239]
    ds_read_b128 v[188:191], v6 offset:880
    v_mfma_f32_16x16x32_bf16 v[240:243], v[196:199], v[204:207], v[240:243]
    ds_read_b128 v[172:175], v5 offset:512
    v_mfma_f32_16x16x32_bf16 v[244:247], v[196:199], v[208:211], v[244:247]
    ds_read_b64 v[228:229], v164 offset:200
    ds_read_b64 v[230:231], v164 offset:232
    s_waitcnt lgkmcnt(5)
    v_mfma_f32_16x16x32_bf16 v[232:235], v[168:171], v[176:179], v[232:235]
    ds_read_b128 v[192:195], v5 offset:1472
    v_mfma_f32_16x16x32_bf16 v[236:239], v[168:171], v[180:183], v[236:239]
    ds_read_b128 v[200:203], v6 offset:96
    s_waitcnt lgkmcnt(5)
    v_mfma_f32_16x16x32_bf16 v[240:243], v[168:171], v[184:187], v[240:243]
    ds_read_b128 v[204:207], v6 offset:352
    v_mfma_f32_16x16x32_bf16 v[244:247], v[168:171], v[188:191], v[244:247]
    ds_read_b128 v[208:211], v6 offset:608
    s_waitcnt lgkmcnt(6)
    v_mfma_f32_16x16x32_bf16 v[236:239], v[172:175], v[176:179], v[236:239]
    ds_read_b128 v[212:215], v6 offset:864
    v_mfma_f32_16x16x32_bf16 v[240:243], v[172:175], v[180:183], v[240:243]
    ds_read_b128 v[196:199], v5 offset:448
    v_mfma_f32_16x16x32_bf16 v[244:247], v[172:175], v[184:187], v[244:247]
    s_waitcnt lgkmcnt(3)
    v_mfma_f32_16x16x32_bf16 v[232:235], v[192:195], v[200:203], v[232:235]
    ds_read_b128 v[168:171], v5 offset:1408
    v_mfma_f32_16x16x32_bf16 v[236:239], v[192:195], v[204:207], v[236:239]
    ds_read_b128 v[176:179], v6 offset:80
    s_waitcnt lgkmcnt(3)
    v_mfma_f32_16x16x32_bf16 v[240:243], v[192:195], v[208:211], v[240:243]
    ds_read_b128 v[180:183], v6 offset:336
    v_mfma_f32_16x16x32_bf16 v[244:247], v[192:195], v[212:215], v[244:247]
    ds_read_b128 v[184:187], v6 offset:592
    v_mfma_f32_16x16x32_bf16 v[240:243], v[116:119], v[216:219], v[240:243]
    v_mfma_f32_16x16x32_bf16 v[244:247], v[116:119], v[224:227], v[244:247]
    s_waitcnt lgkmcnt(4)
    v_mfma_f32_16x16x32_bf16 v[236:239], v[196:199], v[200:203], v[236:239]
    ds_read_b128 v[188:191], v6 offset:848
    v_mfma_f32_16x16x32_bf16 v[240:243], v[196:199], v[204:207], v[240:243]
    ds_read_b128 v[172:175], v5 offset:384
    v_mfma_f32_16x16x32_bf16 v[244:247], v[196:199], v[208:211], v[244:247]
    s_waitcnt lgkmcnt(3)
    v_mfma_f32_16x16x32_bf16 v[232:235], v[168:171], v[176:179], v[232:235]
    ds_read_b128 v[192:195], v5 offset:1344
    v_mfma_f32_16x16x32_bf16 v[236:239], v[168:171], v[180:183], v[236:239]
    ds_read_b128 v[200:203], v6 offset:64
    s_waitcnt lgkmcnt(3)
    v_mfma_f32_16x16x32_bf16 v[240:243], v[168:171], v[184:187], v[240:243]
    ds_read_b128 v[204:207], v6 offset:320
    v_mfma_f32_16x16x32_bf16 v[244:247], v[168:171], v[188:191], v[244:247]
    ds_read_b128 v[208:211], v6 offset:576
    v_mfma_f32_16x16x32_bf16 v[240:243], v[124:127], v[220:223], v[240:243]
    v_mfma_f32_16x16x32_bf16 v[244:247], v[124:127], v[228:231], v[244:247]
    s_waitcnt lgkmcnt(4)
    v_mfma_f32_16x16x32_bf16 v[236:239], v[172:175], v[176:179], v[236:239]
    ds_read_b128 v[212:215], v6 offset:832
    v_mfma_f32_16x16x32_bf16 v[240:243], v[172:175], v[180:183], v[240:243]
    ds_read_b128 v[196:199], v5 offset:320
    v_mfma_f32_16x16x32_bf16 v[244:247], v[172:175], v[184:187], v[244:247]
    s_waitcnt lgkmcnt(3)
    v_mfma_f32_16x16x32_bf16 v[232:235], v[192:195], v[200:203], v[232:235]
    ds_read_b128 v[168:171], v5 offset:1280
    v_mfma_f32_16x16x32_bf16 v[236:239], v[192:195], v[204:207], v[236:239]
    ds_read_b128 v[176:179], v6 offset:48
    s_waitcnt lgkmcnt(3)
    v_mfma_f32_16x16x32_bf16 v[240:243], v[192:195], v[208:211], v[240:243]
    ds_read_b128 v[180:183], v6 offset:304
    v_mfma_f32_16x16x32_bf16 v[244:247], v[192:195], v[212:215], v[244:247]
    ds_read_b128 v[184:187], v6 offset:560
    v_mfma_f32_16x16x32_bf16 v[244:247], v[120:123], v[216:219], v[244:247]
    s_waitcnt lgkmcnt(4)
    v_mfma_f32_16x16x32_bf16 v[236:239], v[196:199], v[200:203], v[236:239]
    ds_read_b128 v[188:191], v6 offset:816
    v_mfma_f32_16x16x32_bf16 v[240:243], v[196:199], v[204:207], v[240:243]
    ds_read_b128 v[172:175], v5 offset:256
    v_mfma_f32_16x16x32_bf16 v[244:247], v[196:199], v[208:211], v[244:247]
    s_waitcnt lgkmcnt(3)
    v_mfma_f32_16x16x32_bf16 v[232:235], v[168:171], v[176:179], v[232:235]
    ds_read_b128 v[192:195], v5 offset:1216
    v_mfma_f32_16x16x32_bf16 v[236:239], v[168:171], v[180:183], v[236:239]
    ds_read_b128 v[200:203], v6 offset:32
    s_waitcnt lgkmcnt(3)
    v_mfma_f32_16x16x32_bf16 v[240:243], v[168:171], v[184:187], v[240:243]
    ds_read_b128 v[204:207], v6 offset:288
    v_mfma_f32_16x16x32_bf16 v[244:247], v[168:171], v[188:191], v[244:247]
    ds_read_b128 v[208:211], v6 offset:544
    v_mfma_f32_16x16x32_bf16 v[244:247], v[128:131], v[220:223], v[244:247]
    s_waitcnt lgkmcnt(4)
    v_mfma_f32_16x16x32_bf16 v[236:239], v[172:175], v[176:179], v[236:239]
    ds_read_b128 v[212:215], v6 offset:800
    v_mfma_f32_16x16x32_bf16 v[240:243], v[172:175], v[180:183], v[240:243]
    ds_read_b128 v[196:199], v5 offset:192
    v_mfma_f32_16x16x32_bf16 v[244:247], v[172:175], v[184:187], v[244:247]
    s_waitcnt lgkmcnt(3)
    v_mfma_f32_16x16x32_bf16 v[232:235], v[192:195], v[200:203], v[232:235]
    ds_read_b128 v[168:171], v5 offset:1152
    v_mfma_f32_16x16x32_bf16 v[236:239], v[192:195], v[204:207], v[236:239]
    ds_read_b128 v[176:179], v6 offset:16
    s_waitcnt lgkmcnt(3)
    v_mfma_f32_16x16x32_bf16 v[240:243], v[192:195], v[208:211], v[240:243]
    ds_read_b128 v[180:183], v6 offset:272
    v_mfma_f32_16x16x32_bf16 v[244:247], v[192:195], v[212:215], v[244:247]
    ds_read_b128 v[184:187], v6 offset:528
    s_waitcnt lgkmcnt(4)
    v_mfma_f32_16x16x32_bf16 v[236:239], v[196:199], v[200:203], v[236:239]
    ds_read_b128 v[188:191], v6 offset:784
    v_mfma_f32_16x16x32_bf16 v[240:243], v[196:199], v[204:207], v[240:243]
    ds_read_b128 v[172:175], v5 offset:128
    v_mfma_f32_16x16x32_bf16 v[244:247], v[196:199], v[208:211], v[244:247]
    s_waitcnt lgkmcnt(3)
    v_mfma_f32_16x16x32_bf16 v[232:235], v[168:171], v[176:179], v[232:235]
    ds_read_b128 v[192:195], v5 offset:1088
    v_mfma_f32_16x16x32_bf16 v[236:239], v[168:171], v[180:183], v[236:239]
    ds_read_b128 v[200:203], v6 offset:0
    s_waitcnt lgkmcnt(3)
    v_mfma_f32_16x16x32_bf16 v[240:243], v[168:171], v[184:187], v[240:243]
    ds_read_b128 v[204:207], v6 offset:256
    v_mfma_f32_16x16x32_bf16 v[244:247], v[168:171], v[188:191], v[244:247]
    ds_read_b128 v[208:211], v6 offset:512
    s_waitcnt lgkmcnt(4)
    v_mfma_f32_16x16x32_bf16 v[236:239], v[172:175], v[176:179], v[236:239]
    ds_read_b128 v[212:215], v6 offset:768
    v_mfma_f32_16x16x32_bf16 v[240:243], v[172:175], v[180:183], v[240:243]
    ds_read_b128 v[196:199], v5 offset:64
    v_mfma_f32_16x16x32_bf16 v[244:247], v[172:175], v[184:187], v[244:247]
    s_waitcnt lgkmcnt(4)
    v_mfma_f32_16x16x32_bf16 v[232:235], v[192:195], v[200:203], v[232:235]
    s_waitcnt lgkmcnt(3)
    v_mfma_f32_16x16x32_bf16 v[236:239], v[192:195], v[204:207], v[236:239]
    s_waitcnt lgkmcnt(0)
    v_mfma_f32_16x16x32_bf16 v[236:239], v[196:199], v[200:203], v[236:239]
    v_mfma_f32_16x16x32_bf16 v[240:243], v[192:195], v[208:211], v[240:243]
    v_mfma_f32_16x16x32_bf16 v[244:247], v[192:195], v[212:215], v[244:247]
    v_mfma_f32_16x16x32_bf16 v[240:243], v[196:199], v[204:207], v[240:243]
    v_mfma_f32_16x16x32_bf16 v[244:247], v[196:199], v[208:211], v[244:247]
    s_nop 3
    v_cvt_pk_bf16_f32 v112, v232, v236
    ds_write_b32 v7, v112 offset:0
    v_cvt_pk_bf16_f32 v113, v233, v237
    ds_write_b32 v7, v113 offset:16
    v_cvt_pk_bf16_f32 v114, v234, v238
    ds_write_b32 v7, v114 offset:32
    v_cvt_pk_bf16_f32 v115, v235, v239
    ds_write_b32 v7, v115 offset:48
    v_cvt_pk_bf16_f32 v116, v240, v244
    ds_write_b32 v7, v116 offset:8
    v_cvt_pk_bf16_f32 v117, v241, v245
    ds_write_b32 v7, v117 offset:24
    v_cvt_pk_bf16_f32 v118, v242, v246
    ds_write_b32 v7, v118 offset:40
    v_cvt_pk_bf16_f32 v119, v243, v247
    ds_write_b32 v7, v119 offset:56
L_conv_out:
    s_waitcnt vmcnt(0)
    s_waitcnt lgkmcnt(0)
    s_barrier
    ds_read_b64 v[112:113], v8
    ds_read_b64 v[114:115], v8 offset:4160
    s_waitcnt lgkmcnt(0)
    v_perm_b32 v116, v114, v112, s62
    v_perm_b32 v117, v115, v113, s62
    v_perm_b32 v118, v114, v112, s63
    v_perm_b32 v119, v115, v113, s63
    buffer_store_dwordx4 v[116:119], v1, s[8:11], s45 offen sc1
    s_add_u32 s44, s44, 2097152
    s_add_u32 s45, s45, 2097152
    s_add_u32 s46, s46, 2097152
    ds_read_b128 v[64:67], v2 offset:0
    ds_read_b128 v[68:71], v2 offset:1024
    ds_read_b128 v[72:75], v2 offset:2048
    ds_read_b128 v[76:79], v2 offset:3072
    ds_read_b128 v[80:83], v2 offset:4096
    ds_read_b128 v[84:87], v2 offset:5120
    ds_read_b128 v[88:91], v2 offset:16384
    ds_read_b128 v[92:95], v2 offset:17408
    ds_read_b128 v[96:99], v2 offset:18432
    ds_read_b128 v[100:103], v2 offset:19456
    s_cmp_lg_u32 s5, 0
    s_cbranch_scc1 L_nodef
    s_cmp_ge_u32 s4, 4
    s_cbranch_scc1 L_nodef
    v_and_b32 v112, 63, v0
    v_and_b32 v115, 1, v0
    v_lshrrev_b32 v116, 5, v112
    v_lshlrev_b32 v121, 4, v115
    v_lshrrev_b32 v117, 1, v0
    v_lshl_add_u32 v11, v117, 6, v121
    v_and_b32 v117, 31, v112
    s_lshl_b32 s6, s4, 5
    v_add_u32 v117, s6, v117
    v_lshlrev_b32 v118, 4, v116
    v_lshl_add_u32 v13, v117, 6, v118
    v_and_b32 v119, 1, v117
    v_lshl_add_u32 v118, v119, 5, v118
    v_lshrrev_b32 v119, 1, v117
    v_lshl_add_u32 v9, v119, 14, v118
    v_mul_u32_u24 v118, 4160, v116
    v_lshlrev_b32 v117, 2, v117
    v_xor_b32 v14, v117, v118
    v_bfe_u32 v117, v112, 2, 2
    v_bfe_u32 v118, v112, 1, 1
    v_lshrrev_b32 v119, 4, v112
    v_lshl_add_u32 v118, v119, 1, v118
    s_and_b32 s6, s4, 1
    s_lshl_b32 s6, s6, 3
    v_add_u32 v118, s6, v118
    s_lshr_b32 s7, s4, 1
    s_lshl_b32 s7, s7, 6
    v_lshl_add_u32 v119, v117, 4, v118
    v_add_u32 v119, s7, v119
    v_lshl_add_u32 v12, v119, 6, v121
    v_lshl_add_u32 v149, v119, 13, v121
    v_lshrrev_b32 v119, 1, v119
    v_lshlrev_b32 v120, 4, v112
    v_and_b32 v120, 48, v120
    v_lshl_add_u32 v10, v119, 14, v120
    v_lshl_add_u32 v119, v118, 2, v117
    v_add_u32 v119, s7, v119
    v_mul_u32_u24 v118, 4160, v115
    v_lshlrev_b32 v119, 2, v119
    v_xor_b32 v15, v119, v118
    v_bfe_u32 v117, v112, 2, 1
    v_bfe_u32 v118, v112, 3, 1
    v_lshlrev_b32 v117, 2, v117
    v_lshl_add_u32 v117, v118, 1, v117
    v_bfe_u32 v118, v112, 1, 1
    v_add_u32 v117, v117, v118
    v_cvt_f32_u32 v118, v115
    v_mul_f32 v121, 0xbe800000, v118
    v_lshl_add_u32 v118, v116, 10, s3
    v_mul_u32_u24 v118, v117, v118
    v_lshlrev_b32 v119, 8, v117
    v_cvt_f32_u32 v118, v118
    v_cvt_f32_u32 v119, v119
    s_mov_b32 s66, 0xba000000
    v_fma_f32 v122, v118, s66, v121
    v_mul_f32 v123, s66, v119
    v_cos_f32 v118, v122
    v_sin_f32 v119, v122
    s_nop 0
    v_cvt_pk_bf16_f32 v36, v118, -v119
    v_add_f32 v122, v122, v123
    v_cos_f32 v118, v122
    v_sin_f32 v119, v122
    s_nop 0
    v_cvt_pk_bf16_f32 v37, v118, -v119
    v_add_f32 v122, v122, v123
    v_cos_f32 v118, v122
    v_sin_f32 v119, v122
    s_nop 0
    v_cvt_pk_bf16_f32 v38, v118, -v119
    v_add_f32 v122, v122, v123
    v_cos_f32 v118, v122
    v_sin_f32 v119, v122
    s_nop 0
    v_cvt_pk_bf16_f32 v39, v118, -v119
    v_lshl_add_u32 v117, v117, 8, s3
    v_lshlrev_b32 v118, 2, v116
    v_mul_u32_u24 v118, v117, v118
    v_cvt_f32_u32 v118, v118
    v_cvt_f32_u32 v119, v117
    s_mov_b32 s66, 0x3a000000
    v_fma_f32 v122, v118, s66, v121
    v_mul_f32 v123, s66, v119
    v_cos_f32 v118, v122
    v_sin_f32 v119, v122
    s_nop 0
    v_cvt_pk_bf16_f32 v40, v118, -v119
    v_add_f32 v122, v122, v123
    v_cos_f32 v118, v122
    v_sin_f32 v119, v122
    s_nop 0
    v_cvt_pk_bf16_f32 v41, v118, -v119
    v_add_f32 v122, v122, v123
    v_cos_f32 v118, v122
    v_sin_f32 v119, v122
    s_nop 0
    v_cvt_pk_bf16_f32 v42, v118, -v119
    v_add_f32 v122, v122, v123
    v_cos_f32 v118, v122
    v_sin_f32 v119, v122
    s_nop 0
    v_cvt_pk_bf16_f32 v43, v118, -v119
    s_branch L_defd
L_nodef:
    s_sleep 8
L_defd:
    v_add_f32 v3, s60, v3
    v_pk_add_f32 v[20:21], v[20:21], s[60:61] op_sel_hi:[1,0] neg_lo:[0,1] neg_hi:[0,1]
    v_pk_fma_f32 v[20:21], v[248:249], v[28:29], v[20:21]
    v_pk_add_f32 v[22:23], v[22:23], s[60:61] op_sel_hi:[1,0] neg_lo:[0,1] neg_hi:[0,1]
    v_pk_fma_f32 v[22:23], v[250:251], v[30:31], v[22:23]
    v_pk_add_f32 v[24:25], v[24:25], s[60:61] op_sel_hi:[1,0] neg_lo:[0,1] neg_hi:[0,1]
    v_pk_fma_f32 v[24:25], v[252:253], v[32:33], v[24:25]
    v_pk_add_f32 v[26:27], v[26:27], s[60:61] op_sel_hi:[1,0] neg_lo:[0,1] neg_hi:[0,1]
    v_pk_fma_f32 v[26:27], v[254:255], v[34:35], v[26:27]
    v_cvt_pk_bf16_f32 v120, v20, v21
    v_cvt_pk_bf16_f32 v121, v22, v23
    v_cvt_pk_bf16_f32 v122, v24, v25
    v_cvt_pk_bf16_f32 v123, v26, v27
    s_waitcnt lgkmcnt(0)
    s_nop 0
    v_mfma_f32_16x16x32_bf16 v[104:107], v[120:123], v[64:67], 0
    v_mfma_f32_16x16x32_bf16 v[108:111], v[120:123], v[68:71], 0
    s_waitcnt lgkmcnt(0)
    s_sleep 7
    buffer_load_dwordx4 v[48:51], v11, s[8:11], s44 offen sc1
    s_waitcnt vmcnt(0)
    ds_write2st64_b32 v17, v48, v49 offset0:88 offset1:92
    ds_write2st64_b32 v17, v50, v51 offset0:96 offset1:100
    v_cmp_eq_u32 vcc, s14, v48
    v_cmp_eq_u32_e64 s[48:49], s14, v49
    v_cmp_eq_u32_e64 s[50:51], s14, v50
    v_cmp_eq_u32_e64 s[52:53], s14, v51
    s_or_b64 vcc, vcc, s[48:49]
    s_or_b64 s[50:51], s[50:51], s[52:53]
    s_or_b64 s[50:51], vcc, s[50:51]
    s_cbranch_scc0 L_pollok1
    s_mov_b64 exec, s[50:51]
    s_mov_b32 s15, 1000000
L_poll1:
    buffer_load_dwordx4 v[48:51], v11, s[8:11], s44 offen sc1
    s_waitcnt vmcnt(0)
    v_cmp_eq_u32 vcc, s14, v48
    v_cmp_eq_u32_e64 s[48:49], s14, v49
    v_cmp_eq_u32_e64 s[50:51], s14, v50
    v_cmp_eq_u32_e64 s[52:53], s14, v51
    s_or_b64 vcc, vcc, s[48:49]
    s_or_b64 s[50:51], s[50:51], s[52:53]
    s_or_b64 exec, vcc, s[50:51]
    s_cbranch_scc0 L_polld1
    s_sub_u32 s15, s15, 1
    s_cbranch_scc0 L_poll1
    s_mov_b64 exec, -1
    v_mov_b32 v103, 8
    global_store_dword v103, v103, s[38:39]
L_polld1:
    s_mov_b64 exec, -1
    ds_write2st64_b32 v17, v48, v49 offset0:88 offset1:92
    ds_write2st64_b32 v17, v50, v51 offset0:96 offset1:100
L_pollok1:
    s_waitcnt lgkmcnt(0)
    s_barrier
    ds_read_b128 v[112:115], v16 offset:22528
    s_cmp_lg_u32 s5, 0
    s_cbranch_scc1 L_r2skip
    buffer_load_dwordx4 v[52:55], v149, s[8:11], s57 offen sc1
    buffer_store_dwordx4 v[44:47], v151, s[8:11], s46 offen sc1
L_r2skip:
    s_waitcnt lgkmcnt(0)
    v_mfma_f32_16x16x32_bf16 v[20:23], v[88:91], v[112:115], v[20:23]
    v_mfma_f32_16x16x32_bf16 v[24:27], v[92:95], v[112:115], v[24:27]
    v_mfma_f32_16x16x32_bf16 v[104:107], v[112:115], v[64:67], v[104:107]
    v_mfma_f32_16x16x32_bf16 v[108:111], v[112:115], v[68:71], v[108:111]
    s_nop 4
    v_pk_mul_f32 v[144:145], v[20:21], v[20:21]
    v_pk_mul_f32 v[146:147], v[24:25], v[24:25]
    v_pk_fma_f32 v[144:145], v[22:23], v[22:23], v[144:145]
    v_pk_fma_f32 v[146:147], v[26:27], v[26:27], v[146:147]
    v_pk_add_f32 v[144:145], v[144:145], v[146:147]
    v_add_f32 v144, v144, v145
    v_pk_mul_f32 v[116:117], v[104:105], v[96:97]
    v_pk_mul_f32 v[120:121], v[108:109], v[96:97]
    v_add_f32_dpp v144, v144, v144 row_ror:8 row_mask:0xf bank_mask:0xf
    v_pk_mul_f32 v[118:119], v[106:107], v[98:99]
    v_pk_mul_f32 v[122:123], v[110:111], v[98:99]
    v_add_f32_dpp v144, v144, v144 row_ror:4 row_mask:0xf bank_mask:0xf
    v_pk_fma_f32 v[116:117], v[108:109], v[100:101], v[116:117]
    v_pk_fma_f32 v[120:121], v[104:105], v[100:101], v[120:121] neg_lo:[1,0,0] neg_hi:[1,0,0]
    v_add_f32_dpp v144, v144, v144 row_ror:2 row_mask:0xf bank_mask:0xf
    v_pk_fma_f32 v[118:119], v[110:111], v[102:103], v[118:119]
    v_pk_fma_f32 v[122:123], v[106:107], v[102:103], v[122:123] neg_lo:[1,0,0] neg_hi:[1,0,0]
    v_add_f32_dpp v144, v144, v144 row_ror:1 row_mask:0xf bank_mask:0xf
    v_cvt_pk_bf16_f32 v124, v116, v120
    v_cvt_pk_bf16_f32 v125, v117, v121
    v_add_f32_dpp v144, v144, v144 row_bcast:15 row_mask:0xa bank_mask:0xf
    v_cvt_pk_bf16_f32 v126, v118, v122
    v_cvt_pk_bf16_f32 v127, v119, v123
    v_add_f32_dpp v144, v144, v144 row_bcast:31 row_mask:0xc bank_mask:0xf
    v_fmamk_f32 v144, v144, 0x3b000000, v165
    v_mfma_f32_16x16x32_bf16 v[140:143], v[84:87], v[124:127], 0
    v_mfma_f32_16x16x32_bf16 v[136:139], v[80:83], v[124:127], 0
    v_mfma_f32_16x16x32_bf16 v[128:131], v[72:75], v[124:127], 0
    v_mfma_f32_16x16x32_bf16 v[132:135], v[76:79], v[124:127], 0
    s_nop 4
    v_readlane_b32 s60, v140, 0
    v_writelane_b32 v140, 0, 0
    s_nop 0
    v_fma_f32 v144, -s60, s60, v144
    v_max_f32 v144, v165, v144
    v_rsq_f32 v144, v144
    s_nop 0
    v_readlane_b32 s58, v144, 63
    s_nop 1
    v_pk_mul_f32 v[128:129], v[128:129], s[58:59] op_sel_hi:[1,0]
    v_pk_mul_f32 v[130:131], v[130:131], s[58:59] op_sel_hi:[1,0]
    v_pk_mul_f32 v[132:133], v[132:133], s[58:59] op_sel_hi:[1,0]
    v_pk_mul_f32 v[134:135], v[134:135], s[58:59] op_sel_hi:[1,0]
    s_mov_b64 exec, s[54:55]
    v_pk_mul_f32 v[128:129], v[136:137], s[58:59] op_sel_hi:[1,0]
    v_pk_mul_f32 v[130:131], v[138:139], s[58:59] op_sel_hi:[1,0]
    v_pk_mul_f32 v[132:133], v[140:141], s[58:59] op_sel_hi:[1,0]
    v_pk_mul_f32 v[134:135], v[142:143], s[58:59] op_sel_hi:[1,0]
    s_mov_b64 exec, -1
    v_cvt_pk_bf16_f32 v124, v128, v132
    v_cvt_pk_bf16_f32 v125, v129, v133
    v_cvt_pk_bf16_f32 v126, v130, v134
    v_cvt_pk_bf16_f32 v127, v131, v135
    ds_write_b128 v16, v[124:127] offset:22528
    s_waitcnt lgkmcnt(0)
    s_barrier
    ds_read2st64_b32 v[112:113], v14 offset0:88 offset1:92
    ds_read2st64_b32 v[114:115], v14 offset0:96 offset1:100
    s_waitcnt lgkmcnt(0)
    v_mfma_f32_32x32x16_bf16 v[128:143], v[36:39], v[112:115], 0
    s_nop 11
    v_cvt_pk_bf16_f32 v124, v128, v129
    v_cvt_pk_bf16_f32 v125, v130, v131
    v_cvt_pk_bf16_f32 v126, v132, v133
    v_cvt_pk_bf16_f32 v127, v134, v135
    buffer_store_dwordx4 v[124:127], v9, s[8:11], s45 offen sc1
    s_add_u32 s44, s44, 2097152
    s_add_u32 s45, s45, 2097152
    s_add_u32 s46, s46, 2097152
    ds_read_b128 v[64:67], v2 offset:6144
    ds_read_b128 v[68:71], v2 offset:7168
    ds_read_b128 v[72:75], v2 offset:8192
    ds_read_b128 v[76:79], v2 offset:9216
    ds_read_b128 v[80:83], v2 offset:20480
    ds_read_b128 v[84:87], v2 offset:21504
    s_cmp_lg_u32 s5, 0
    s_cbranch_scc1 L_wskip
    s_waitcnt vmcnt(2)
    ds_write2st64_b32 v15, v52, v53 offset0:152 offset1:156
    ds_write2st64_b32 v15, v54, v55 offset0:160 offset1:164
L_wskip:
    s_waitcnt lgkmcnt(0)
    s_sleep 19
    buffer_load_dwordx4 v[48:51], v12, s[8:11], s44 offen sc1
    s_waitcnt vmcnt(0)
    ds_write2st64_b32 v15, v48, v49 offset0:120 offset1:124
    ds_write2st64_b32 v15, v50, v51 offset0:128 offset1:132
    v_cmp_eq_u32 vcc, s14, v48
    v_cmp_eq_u32_e64 s[48:49], s14, v49
    v_cmp_eq_u32_e64 s[50:51], s14, v50
    v_cmp_eq_u32_e64 s[52:53], s14, v51
    s_or_b64 vcc, vcc, s[48:49]
    s_or_b64 s[50:51], s[50:51], s[52:53]
    s_or_b64 s[50:51], vcc, s[50:51]
    s_cbranch_scc0 L_pollok2
    s_mov_b64 exec, s[50:51]
    s_mov_b32 s15, 1000000
L_poll2:
    buffer_load_dwordx4 v[48:51], v12, s[8:11], s44 offen sc1
    s_waitcnt vmcnt(0)
    v_cmp_eq_u32 vcc, s14, v48
    v_cmp_eq_u32_e64 s[48:49], s14, v49
    v_cmp_eq_u32_e64 s[50:51], s14, v50
    v_cmp_eq_u32_e64 s[52:53], s14, v51
    s_or_b64 vcc, vcc, s[48:49]
    s_or_b64 s[50:51], s[50:51], s[52:53]
    s_or_b64 exec, vcc, s[50:51]
    s_cbranch_scc0 L_polld2
    s_sub_u32 s15, s15, 1
    s_cbranch_scc0 L_poll2
    s_mov_b64 exec, -1
    v_mov_b32 v103, 12
    global_store_dword v103, v103, s[38:39]
L_polld2:
    s_mov_b64 exec, -1
    ds_write2st64_b32 v15, v48, v49 offset0:120 offset1:124
    ds_write2st64_b32 v15, v50, v51 offset0:128 offset1:132
L_pollok2:
    s_cmp_lg_u32 s5, 0
    s_cbranch_scc1 L_nopo0
    buffer_store_dwordx4 v[44:47], v151, s[8:11], s46 offen sc1
L_nopo0:
    s_waitcnt lgkmcnt(0)
    s_barrier
    ds_read_b128 v[112:115], v16 offset:30720
    s_cmp_lg_u32 s5, 0
    s_cbranch_scc1 L_whave
    ds_read_b128 v[52:55], v16 offset:38912
    s_waitcnt lgkmcnt(0)
    v_lshlrev_b32 v56, 16, v52
    v_and_b32 v60, 0xffff0000, v52
    v_lshlrev_b32 v57, 16, v53
    v_and_b32 v61, 0xffff0000, v53
    v_lshlrev_b32 v58, 16, v54
    v_and_b32 v62, 0xffff0000, v54
    v_lshlrev_b32 v59, 16, v55
    v_and_b32 v63, 0xffff0000, v55
L_whave:
    s_waitcnt lgkmcnt(0)
    v_mfma_f32_16x16x32_bf16 v[124:127], v[112:115], v[64:67], 0
    v_mfma_f32_16x16x32_bf16 v[128:131], v[112:115], v[68:71], 0
    s_nop 6
    v_pk_mul_f32 v[116:117], v[124:125], v[80:81]
    v_pk_mul_f32 v[120:121], v[128:129], v[80:81]
    v_pk_mul_f32 v[118:119], v[126:127], v[82:83]
    v_pk_mul_f32 v[122:123], v[130:131], v[82:83]
    v_pk_fma_f32 v[116:117], v[128:129], v[84:85], v[116:117]
    v_pk_fma_f32 v[120:121], v[124:125], v[84:85], v[120:121] neg_lo:[1,0,0] neg_hi:[1,0,0]
    v_pk_fma_f32 v[118:119], v[130:131], v[86:87], v[118:119]
    v_pk_fma_f32 v[122:123], v[126:127], v[86:87], v[122:123] neg_lo:[1,0,0] neg_hi:[1,0,0]
    v_cvt_pk_bf16_f32 v112, v116, v120
    v_cvt_pk_bf16_f32 v113, v117, v121
    v_cvt_pk_bf16_f32 v114, v118, v122
    v_cvt_pk_bf16_f32 v115, v119, v123
    s_nop 1
    v_mfma_f32_16x16x32_bf16 v[124:127], v[64:67], v[112:115], 0
    v_mfma_f32_16x16x32_bf16 v[128:131], v[68:71], v[112:115], 0
    s_nop 6
    v_pk_mul_f32 v[116:117], v[124:125], v[56:57]
    v_pk_mul_f32 v[120:121], v[128:129], v[56:57]
    v_pk_mul_f32 v[118:119], v[126:127], v[58:59]
    v_pk_mul_f32 v[122:123], v[130:131], v[58:59]
    v_pk_fma_f32 v[116:117], v[128:129], v[60:61], v[116:117] neg_lo:[1,0,0] neg_hi:[1,0,0]
    v_pk_fma_f32 v[120:121], v[124:125], v[60:61], v[120:121]
    v_pk_fma_f32 v[118:119], v[130:131], v[62:63], v[118:119] neg_lo:[1,0,0] neg_hi:[1,0,0]
    v_pk_fma_f32 v[122:123], v[126:127], v[62:63], v[122:123]
    v_cvt_pk_bf16_f32 v112, v116, v120
    v_cvt_pk_bf16_f32 v113, v117, v121
    v_cvt_pk_bf16_f32 v114, v118, v122
    v_cvt_pk_bf16_f32 v115, v119, v123
    s_nop 1
    v_mfma_f32_16x16x32_bf16 v[124:127], v[112:115], v[72:75], 0
    v_mfma_f32_16x16x32_bf16 v[128:131], v[112:115], v[76:79], 0
    s_nop 6
    v_pk_mul_f32 v[116:117], v[124:125], v[80:81]
    v_pk_mul_f32 v[120:121], v[128:129], v[80:81]
    v_pk_mul_f32 v[118:119], v[126:127], v[82:83]
    v_pk_mul_f32 v[122:123], v[130:131], v[82:83]
    v_pk_fma_f32 v[116:117], v[128:129], v[84:85], v[116:117] neg_lo:[1,0,0] neg_hi:[1,0,0]
    v_pk_fma_f32 v[120:121], v[124:125], v[84:85], v[120:121]
    v_pk_fma_f32 v[118:119], v[130:131], v[86:87], v[118:119] neg_lo:[1,0,0] neg_hi:[1,0,0]
    v_pk_fma_f32 v[122:123], v[126:127], v[86:87], v[122:123]
    v_cvt_pk_bf16_f32 v112, v116, v120
    v_cvt_pk_bf16_f32 v113, v117, v121
    v_cvt_pk_bf16_f32 v114, v118, v122
    v_cvt_pk_bf16_f32 v115, v119, v123
    s_nop 1
    v_mfma_f32_16x16x32_bf16 v[124:127], v[72:75], v[112:115], 0
    v_mfma_f32_16x16x32_bf16 v[128:131], v[76:79], v[112:115], 0
    s_nop 7
    v_cvt_pk_bf16_f32 v112, v124, v128
    v_cvt_pk_bf16_f32 v113, v125, v129
    v_cvt_pk_bf16_f32 v114, v126, v130
    v_cvt_pk_bf16_f32 v115, v127, v131
    ds_write_b128 v16, v[112:115] offset:30720
    s_waitcnt lgkmcnt(0)
    s_barrier
    ds_read2st64_b32 v[116:117], v15 offset0:120 offset1:124
    ds_read2st64_b32 v[118:119], v15 offset0:128 offset1:132
    s_waitcnt lgkmcnt(0)
    buffer_store_dwordx4 v[116:119], v10, s[8:11], s45 offen sc1
    s_add_u32 s44, s44, 2097152
    s_add_u32 s45, s45, 2097152
    s_add_u32 s46, s46, 2097152
    ds_read_b128 v[64:67], v2 offset:10240
    ds_read_b128 v[68:71], v2 offset:11264
    ds_read_b128 v[72:75], v2 offset:12288
    ds_read_b128 v[76:79], v2 offset:13312
    ds_read_b128 v[80:83], v2 offset:14336
    ds_read_b128 v[84:87], v2 offset:15360
    ds_read_b128 v[88:91], v2 offset:18432
    ds_read_b128 v[92:95], v2 offset:19456
    v_add_f32 v3, s60, v3
    v_pk_add_f32 v[20:21], v[20:21], s[60:61] op_sel_hi:[1,0] neg_lo:[0,1] neg_hi:[0,1]
    v_pk_add_f32 v[22:23], v[22:23], s[60:61] op_sel_hi:[1,0] neg_lo:[0,1] neg_hi:[0,1]
    v_pk_add_f32 v[24:25], v[24:25], s[60:61] op_sel_hi:[1,0] neg_lo:[0,1] neg_hi:[0,1]
    v_pk_add_f32 v[26:27], v[26:27], s[60:61] op_sel_hi:[1,0] neg_lo:[0,1] neg_hi:[0,1]
    v_and_b32 v120, 1, v0
    v_mov_b32 v149, 0x05040100
    v_mov_b32 v122, 0x03020706
    v_cmp_eq_u32_e64 s[48:49], 1, v120
    v_lshlrev_b32 v120, 5, v120
    v_bfe_u32 v124, v166, 2, 3
    v_and_b32 v148, 0x180, v166
    v_lshl_add_u32 v148, v124, 2, v148
    v_add_u32 v148, v148, v120
    v_cndmask_b32_e64 v149, v149, v122, s[48:49]
    s_waitcnt lgkmcnt(0)
    s_sleep 18
    buffer_load_dwordx4 v[48:51], v13, s[8:11], s44 offen sc1
    s_waitcnt vmcnt(0)
    v_mfma_f32_32x32x16_bf16 v[128:143], v[40:43], v[48:51], 0
    v_cmp_eq_u32 vcc, s14, v48
    v_cmp_eq_u32_e64 s[48:49], s14, v49
    v_cmp_eq_u32_e64 s[50:51], s14, v50
    v_cmp_eq_u32_e64 s[52:53], s14, v51
    s_or_b64 vcc, vcc, s[48:49]
    s_or_b64 s[50:51], s[50:51], s[52:53]
    s_or_b64 s[50:51], vcc, s[50:51]
    s_cbranch_scc0 L_pollok3
    s_mov_b64 exec, s[50:51]
    s_mov_b32 s15, 1000000
L_poll3:
    buffer_load_dwordx4 v[48:51], v13, s[8:11], s44 offen sc1
    s_waitcnt vmcnt(0)
    v_cmp_eq_u32 vcc, s14, v48
    v_cmp_eq_u32_e64 s[48:49], s14, v49
    v_cmp_eq_u32_e64 s[50:51], s14, v50
    v_cmp_eq_u32_e64 s[52:53], s14, v51
    s_or_b64 vcc, vcc, s[48:49]
    s_or_b64 s[50:51], s[50:51], s[52:53]
    s_or_b64 exec, vcc, s[50:51]
    s_cbranch_scc0 L_polld3
    s_sub_u32 s15, s15, 1
    s_cbranch_scc0 L_poll3
    s_mov_b64 exec, -1
    v_mov_b32 v103, 16
    global_store_dword v103, v103, s[38:39]
L_polld3:
    s_mov_b64 exec, -1
    v_mfma_f32_32x32x16_bf16 v[128:143], v[40:43], v[48:51], 0
    s_nop 7
L_pollok3:
    s_nop 3
    v_cvt_pk_bf16_f32 v112, v128, v129
    v_cvt_pk_bf16_f32 v113, v130, v131
    ds_write2st64_b32 v14, v112, v113 offset0:88 offset1:92
    v_cvt_pk_bf16_f32 v114, v132, v133
    v_cvt_pk_bf16_f32 v115, v134, v135
    ds_write2st64_b32 v14, v114, v115 offset0:96 offset1:100
    s_cmp_lg_u32 s5, 0
    s_cbranch_scc1 L_nopo1
    buffer_store_dwordx4 v[44:47], v151, s[8:11], s46 offen sc1
L_nopo1:
    s_waitcnt lgkmcnt(0)
    s_barrier
    ds_read_b128 v[112:115], v16 offset:22528
    s_waitcnt lgkmcnt(0)
    v_mfma_f32_16x16x32_bf16 v[136:139], v[112:115], v[72:75], 0
    v_mfma_f32_16x16x32_bf16 v[140:143], v[112:115], v[76:79], 0
    v_mfma_f32_16x16x32_bf16 v[128:131], v[112:115], v[64:67], 0
    v_mfma_f32_16x16x32_bf16 v[132:135], v[112:115], v[68:71], 0
    s_mov_b64 exec, 0xffff
    s_nop 5
    v_mov_b32 v128, v136
    v_mov_b32 v132, v140
    s_mov_b64 exec, -1
    v_pk_mul_f32 v[116:117], v[128:129], v[88:89]
    v_pk_mul_f32 v[120:121], v[132:133], v[88:89]
    v_pk_mul_f32 v[118:119], v[130:131], v[90:91]
    v_pk_mul_f32 v[122:123], v[134:135], v[90:91]
    v_pk_fma_f32 v[116:117], v[132:133], v[92:93], v[116:117] neg_lo:[1,0,0] neg_hi:[1,0,0]
    v_pk_fma_f32 v[120:121], v[128:129], v[92:93], v[120:121]
    v_pk_fma_f32 v[118:119], v[134:135], v[94:95], v[118:119] neg_lo:[1,0,0] neg_hi:[1,0,0]
    v_pk_fma_f32 v[122:123], v[130:131], v[94:95], v[122:123]
    v_cvt_pk_bf16_f32 v124, v116, v120
    v_cvt_pk_bf16_f32 v125, v117, v121
    v_cvt_pk_bf16_f32 v126, v118, v122
    v_cvt_pk_bf16_f32 v127, v119, v123
    s_nop 1
    v_mfma_f32_16x16x32_bf16 v[20:23], v[80:83], v[124:127], v[20:23]
    v_mfma_f32_16x16x32_bf16 v[24:27], v[84:87], v[124:127], v[24:27]
    s_cmp_lg_u32 s5, 0
    s_cbranch_scc1 L_final
    s_mov_b32 s5, 1
    s_nop 7
    s_branch L_LN
L_final:
    s_nop 6
    v_add_f32 v20, v20, v3
    v_add_f32 v21, v21, v3
    v_add_f32 v22, v22, v3
    v_add_f32 v23, v23, v3
    v_add_f32 v24, v24, v3
    v_add_f32 v25, v25, v3
    v_add_f32 v26, v26, v3
    v_add_f32 v27, v27, v3
    v_cvt_pk_bf16_f32 v112, v20, v21
    v_cvt_pk_bf16_f32 v113, v22, v23
    v_cvt_pk_bf16_f32 v114, v24, v25
    v_cvt_pk_bf16_f32 v115, v26, v27
    v_mov_b32_dpp v116, v112 quad_perm:[1,0,3,2] row_mask:0xf bank_mask:0xf
    v_mov_b32_dpp v117, v113 quad_perm:[1,0,3,2] row_mask:0xf bank_mask:0xf
    v_mov_b32_dpp v118, v114 quad_perm:[1,0,3,2] row_mask:0xf bank_mask:0xf
    v_mov_b32_dpp v119, v115 quad_perm:[1,0,3,2] row_mask:0xf bank_mask:0xf
    v_perm_b32 v116, v116, v112, v149
    global_store_dword v148, v116, s[36:37] offset:0 sc1
    v_perm_b32 v117, v117, v113, v149
    global_store_dword v148, v117, s[36:37] offset:64 sc1
    v_perm_b32 v118, v118, v114, v149
    global_store_dword v148, v118, s[36:37] offset:512 sc1
    v_perm_b32 v119, v119, v115, v149
    global_store_dword v148, v119, s[36:37] offset:576 sc1
    s_add_u32 s6, s4, s3
    s_cmp_lg_u32 s6, 0
    s_cbranch_scc1 L_noep
    v_add_u32 v152, 1, v152
    v_mov_b32 v112, 0
    buffer_store_dword v152, v112, s[8:11], 0 offen sc1
L_noep:
L_end:
    s_endpgm
L_code_end:
.p2align 8
.type L_band,@object
L_band:
    .long 0x3f803f80,0x3f803f80,0x3f803f80,0x3f803f80,0x3f800000,0x3f803f80,0x3f803f80,0x3f803f80
    .long 0x0,0x3f803f80,0x3f803f80,0x3f803f80,0x0,0x3f800000,0x3f803f80,0x3f803f80
    .long 0x0,0x0,0x3f803f80,0x3f803f80,0x0,0x0,0x3f800000,0x3f803f80
    .long 0x0,0x0,0x0,0x3f803f80,0x0,0x0,0x0,0x3f800000
    .long 0x0,0x0,0x0,0x0,0x0,0x0,0x0,0x0
    .long 0x0,0x0,0x0,0x0,0x0,0x0,0x0,0x0
    .long 0x0,0x0,0x0,0x0,0x0,0x0,0x0,0x0
    .long 0x0,0x0,0x0,0x0,0x0,0x0,0x0,0x0
    .long 0x3f80,0x0,0x0,0x0,0x3f803f80,0x0,0x0,0x0
    .long 0x3f803f80,0x3f80,0x0,0x0,0x3f803f80,0x3f803f80,0x0,0x0
    .long 0x3f803f80,0x3f803f80,0x3f80,0x0,0x3f803f80,0x3f803f80,0x3f803f80,0x0
    .long 0x3f803f80,0x3f803f80,0x3f803f80,0x3f80,0x3f803f80,0x3f803f80,0x3f803f80,0x3f803f80
    .long 0x3f803f80,0x3f803f80,0x3f803f80,0x3f803f80,0x3f800000,0x3f803f80,0x3f803f80,0x3f803f80
    .long 0x0,0x3f803f80,0x3f803f80,0x3f803f80,0x0,0x3f800000,0x3f803f80,0x3f803f80
    .long 0x0,0x0,0x3f803f80,0x3f803f80,0x0,0x0,0x3f800000,0x3f803f80
    .long 0x0,0x0,0x0,0x3f803f80,0x0,0x0,0x0,0x3f800000
    .long 0x0,0x0,0x0,0x0,0x0,0x0,0x0,0x0
    .long 0x0,0x0,0x0,0x0,0x0,0x0,0x0,0x0
    .long 0x0,0x0,0x0,0x0,0x0,0x0,0x0,0x0
    .long 0x0,0x0,0x0,0x0,0x0,0x0,0x0,0x0
    .long 0x3f80,0x0,0x0,0x0,0x3f803f80,0x0,0x0,0x0
    .long 0x3f803f80,0x3f80,0x0,0x0,0x3f803f80,0x3f803f80,0x0,0x0
    .long 0x3f803f80,0x3f803f80,0x3f80,0x0,0x3f803f80,0x3f803f80,0x3f803f80,0x0
    .long 0x3f803f80,0x3f803f80,0x3f803f80,0x3f80,0x3f803f80,0x3f803f80,0x3f803f80,0x3f803f80
    .long 0x0,0x0,0x0,0x0,0x0,0x0,0x0,0x0
    .long 0x0,0x0,0x0,0x0,0x0,0x0,0x0,0x0
    .long 0x0,0x0,0x0,0x0,0x0,0x0,0x0,0x0
    .long 0x0,0x0,0x0,0x0,0x0,0x0,0x0,0x0
    .long 0x0,0x0,0x0,0x0,0x0,0x0,0x0,0x0
    .long 0x0,0x0,0x0,0x0,0x0,0x0,0x0,0x0
    .long 0x0,0x0,0x0,0x0,0x0,0x0,0x0,0x0
    .long 0x0,0x0,0x0,0x0,0x0,0x0,0x0,0x0
    .long 0x0,0x0,0x0,0x0,0x0,0x0,0x0,0x0
    .long 0x0,0x0,0x0,0x0,0x0,0x0,0x0,0x0
    .long 0x0,0x0,0x0,0x0,0x0,0x0,0x0,0x0
    .long 0x0,0x0,0x0,0x0,0x0,0x0,0x0,0x0
    .long 0x0,0x0,0x0,0x0,0x0,0x0,0x0,0x0
    .long 0x0,0x0,0x0,0x0,0x0,0x0,0x0,0x0
    .long 0x0,0x0,0x0,0x0,0x0,0x0,0x0,0x0
    .long 0x0,0x0,0x0,0x0,0x0,0x0,0x0,0x0
    .long 0x3f800000,0x3f803f80,0x3f803f80,0x3f803f80,0x0,0x3f803f80,0x3f803f80,0x3f803f80
    .long 0x0,0x3f800000,0x3f803f80,0x3f803f80,0x0,0x0,0x3f803f80,0x3f803f80
    .long 0x0,0x0,0x3f800000,0x3f803f80,0x0,0x0,0x0,0x3f803f80
    .long 0x0,0x0,0x0,0x3f800000,0x0,0x0,0x0,0x0
    .long 0x0,0x0,0x0,0x0,0x0,0x0,0x0,0x0
    .long 0x0,0x0,0x0,0x0,0x0,0x0,0x0,0x0
    .long 0x0,0x0,0x0,0x0,0x0,0x0,0x0,0x0
    .long 0x0,0x0,0x0,0x0,0x0,0x0,0x0,0x0
    .long 0x0,0x0,0x0,0x0,0x3f80,0x0,0x0,0x0
    .long 0x3f803f80,0x0,0x0,0x0,0x3f803f80,0x3f80,0x0,0x0
    .long 0x3f803f80,0x3f803f80,0x0,0x0,0x3f803f80,0x3f803f80,0x3f80,0x0
    .long 0x3f803f80,0x3f803f80,0x3f803f80,0x0,0x3f803f80,0x3f803f80,0x3f803f80,0x3f80
    .long 0x3f800000,0x3f803f80,0x3f803f80,0x3f803f80,0x0,0x3f803f80,0x3f803f80,0x3f803f80
    .long 0x0,0x3f800000,0x3f803f80,0x3f803f80,0x0,0x0,0x3f803f80,0x3f803f80
    .long 0x0,0x0,0x3f800000,0x3f803f80,0x0,0x0,0x0,0x3f803f80
    .long 0x0,0x0,0x0,0x3f800000,0x0,0x0,0x0,0x0
    .long 0x0,0x0,0x0,0x0,0x0,0x0,0x0,0x0
    .long 0x0,0x0,0x0,0x0,0x0,0x0,0x0,0x0
    .long 0x0,0x0,0x0,0x0,0x0,0x0,0x0,0x0
    .long 0x0,0x0,0x0,0x0,0x0,0x0,0x0,0x0
    .long 0x0,0x0,0x0,0x0,0x3f80,0x0,0x0,0x0
    .long 0x3f803f80,0x0,0x0,0x0,0x3f803f80,0x3f80,0x0,0x0
    .long 0x3f803f80,0x3f803f80,0x0,0x0,0x3f803f80,0x3f803f80,0x3f80,0x0
    .long 0x3f803f80,0x3f803f80,0x3f803f80,0x0,0x3f803f80,0x3f803f80,0x3f803f80,0x3f80
.size L_band, 2048
.p2align 8
.type L_table,@object
L_table:
    .long 0x3f803f80,0x3f803f80,0x3f803f80,0x3f803f80,0x3f7b3f80,0x3f553f6d,0xbf7bbf80,0xbf55bf6d
    .long 0x3f6d3f80,0x3ec43f35,0x3f6d3f80,0x3ec43f35,0x3f553f80,0xbe483ec4,0xbf55bf80,0x3e48bec4
    .long 0x3f353f80,0xbf35248d,0x3f353f80,0xbf35261f,0x3f0e3f80,0xbf7bbec4,0xbf0ebf80,0x3f7b3ec4
    .long 0x3ec43f80,0xbf6dbf35,0x3ec43f80,0xbf6dbf35,0x3e483f80,0xbf0ebf6d,0xbe48bf80,0x3f0e3f6d
    .long 0x248d3f80,0xa554bf80,0xa6543f80,0xa754bf80,0xbe483f80,0x3f0ebf6d,0x3e48bf80,0xbf0e3f6d
    .long 0xbec43f80,0x3f6dbf35,0xbec43f80,0x3f6dbf35,0xbf0e3f80,0x3f7bbec4,0x3f0ebf80,0xbf7b3ec4
    .long 0xbf353f80,0x3f35a554,0xbf353f80,0x3f35a777,0xbf553f80,0x3e483ec4,0x3f55bf80,0xbe48bec4
    .long 0xbf6d3f80,0xbec43f35,0xbf6d3f80,0xbec43f35,0xbf7b3f80,0xbf553f6d,0x3f7bbf80,0x3f55bf6d
    .long 0x3f803f80,0x3f803f80,0x3f803f80,0x3f803f80,0x3f0e3f35,0x3e483ec4,0xbf0ebf35,0xbe48bec4
    .long 0xbec4248d,0xbf6dbf35,0xbec425b0,0xbf6dbf35,0xbf7bbf35,0xbf0ebf6d,0x3f7b3f35,0x3f0e3f6d
    .long 0xbf35bf80,0x3f35a554,0xbf35bf80,0x3f35a731,0x3e48bf35,0x3f553f6d,0xbe483f35,0xbf55bf6d
    .long 0x3f6da554,0xbec43f35,0x3f6da742,0xbec43f35,0x3f553f35,0xbf7bbec4,0xbf55bf35,0x3f7b3ec4
    .long 0x25b03f80,0xa5f7bf80,0xa60d3f80,0xa765bf80,0xbf553f35,0x3f7bbec4,0x3f55bf35,0xbf7b3ec4
    .long 0xbf6d25b0,0x3ec43f35,0xbf6da58e,0x3ec43f35,0xbe48bf35,0xbf553f6d,0x3e483f35,0x3f55bf6d
    .long 0x3f35bf80,0xbf35261f,0x3f35bf80,0xbf35258d,0x3f7bbf35,0x3f0ebf6d,0xbf7b3f35,0xbf0e3f6d
    .long 0x3ec4a5f7,0x3f6dbf35,0x3ec4a78d,0x3f6dbf35,0xbf0e3f35,0xbe483ec4,0x3f0ebf35,0x3e48bec4
    .long 0x3f803f80,0x3f803f80,0x3f803f80,0x3f803f80,0xbe48248d,0xbf0ebec4,0x3e48a554,0x3f0e3ec4
    .long 0xbf6dbf80,0xbec4bf35,0xbf6dbf80,0xbec4bf35,0x3f0ea554,0x3f7b3f6d,0xbf0e261f,0xbf7bbf6d
    .long 0x3f353f80,0xbf3525b0,0x3f353f80,0xbf35a68d,0xbf5525b0,0xbe48bf6d,0x3f55a742,0x3e483f6d
    .long 0xbec4bf80,0x3f6d3f35,0xbec4bf80,0x3f6d3f35,0x3f7ba5f7,0xbf553ec4,0xbf7ba60d,0x3f55bec4
    .long 0x261f3f80,0xa731bf80,0xa58e3f80,0xa777bf80,0xbf7b261f,0x3f553ec4,0x3f7ba777,0xbf55bec4
    .long 0x3ec4bf80,0xbf6d3f35,0x3ec4bf80,0xbf6d3f35,0x3f55a731,0x3e48bf6d,0xbf552804,0xbe483f6d
    .long 0xbf353f80,0x3f35a742,0xbf353f80,0x3f35a796,0xbf0ea68d,0xbf7b3f6d,0x3f0e2754,0x3f7bbf6d
    .long 0x3f6dbf80,0x3ec4bf35,0x3f6dbf80,0x3ec4bf35,0x3e48a742,0x3f0ebec4,0xbe482889,0xbf0e3ec4
    .long 0x3f803f80,0x3f803f80,0x3f803f80,0x3f803f80,0xbf55bf35,0xbf7bbf6d,0x3f553f35,0x3f7b3f6d
    .long 0x3ec4a554,0x3f6d3f35,0x3ec4a5f7,0x3f6d3f35,0x3e483f35,0xbf55bec4,0xbe48bf35,0x3f553ec4
    .long 0xbf35bf80,0x3f35a5f7,0xbf35bf80,0x3f35a742,0x3f7b3f35,0xbf0e3ec4,0xbf7bbf35,0x3f0ebec4
    .long 0xbf6d261f,0x3ec4bf35,0xbf6da60d,0x3ec4bf35,0x3f0ebf35,0xbe483f6d,0xbf0e3f35,0x3e48bf6d
    .long 0xa68d3f80,0xa742bf80,0xa1373f80,0xa784bf80,0xbf0ebf35,0x3e483f6d,0x3f0e3f35,0xbe48bf6d
    .long 0x3f6da742,0xbec4bf35,0x3f6da78d,0xbec4bf35,0xbf7b3f35,0x3f0e3ec4,0x3f7bbf35,0xbf0ebec4
    .long 0x3f35bf80,0xbf35a60d,0x3f35bf80,0xbf35268d,0xbe483f35,0x3f55bec4,0x3e48bf35,0xbf553ec4
    .long 0xbec4a60d,0xbf6d3f35,0xbec42816,0xbf6d3f35,0x3f55bf35,0x3f7bbf6d,0xbf553f35,0xbf7b3f6d
    .long 0xbf803f80,0xbf803f80,0xbf803f80,0xbf803f80,0xbe488000,0xbf0ebec4,0x3e48a50d,0x3f0e3ec4
    .long 0xbec48000,0xbf6dbf35,0xbec4258d,0xbf6dbf35,0xbf0e8000,0xbf7bbf6d,0x3f0ea5d4,0x3f7b3f6d
    .long 0xbf358000,0xbf35bf80,0xbf35260d,0xbf35bf80,0xbf558000,0xbe48bf6d,0x3f55a630,0x3e483f6d
    .long 0xbf6d8000,0x3ec4bf35,0xbf6d2654,0x3ec4bf35,0xbf7b8000,0x3f55bec4,0x3f7ba677,0xbf553ec4
    .long 0xbf808000,0x3f80a50d,0xbf80268d,0x3f80a69f,0xbf7b8000,0x3f553ec4,0x3f7ba69f,0xbf55bec4
    .long 0xbf6d8000,0x3ec43f35,0xbf6d26b0,0x3ec43f35,0xbf558000,0xbe483f6d,0x3f55a7b1,0x3e48bf6d
    .long 0xbf358000,0xbf353f80,0xbf3526d4,0xbf353f80,0xbf0e8000,0xbf7b3f6d,0x3f0e270d,0x3f7bbf6d
    .long 0xbec48000,0xbf6d3f35,0xbec426f7,0xbf6d3f35,0xbe488000,0xbf0e3ec4,0x3e48a7c2,0x3f0ebec4
    .long 0xbf803f80,0xbf803f80,0xbf803f80,0xbf803f80,0xbf55bf35,0xbf7bbf6d,0x3f553f35,0x3f7b3f6d
    .long 0xbf6dbf80,0xbec4bf35,0xbf6dbf80,0xbec4bf35,0xbe48bf35,0x3f553ec4,0x3e483f35,0xbf55bec4
    .long 0x3f35a50d,0x3f353f80,0x3f35a630,0x3f353f80,0x3f7b3f35,0xbf0e3ec4,0xbf7bbf35,0x3f0ebec4
    .long 0x3ec43f80,0xbf6dbf35,0x3ec43f80,0xbf6dbf35,0xbf0e3f35,0x3e48bf6d,0x3f0ebf35,0xbe483f6d
    .long 0xbf80258d,0x3f80a5d4,0xbf8026b0,0x3f80a7b1,0xbf0ebf35,0x3e483f6d,0x3f0e3f35,0xbe48bf6d
    .long 0x3ec4bf80,0xbf6d3f35,0x3ec4bf80,0xbf6d3f35,0x3f7bbf35,0xbf0ebec4,0xbf7b3f35,0x3f0e3ec4
    .long 0x3f35a5d4,0x3f35bf80,0x3f35a7c2,0x3f35bf80,0xbe483f35,0x3f55bec4,0x3e48bf35,0xbf553ec4
    .long 0xbf6d3f80,0xbec43f35,0xbf6d3f80,0xbec43f35,0xbf553f35,0xbf7b3f6d,0x3f55bf35,0x3f7bbf6d
    .long 0xbf803f80,0xbf803f80,0xbf803f80,0xbf803f80,0xbf7bbf80,0xbf55bf6d,0x3f7b3f80,0x3f553f6d
    .long 0x3ec4a50d,0x3f6d3f35,0x3ec4a5d4,0x3f6d3f35,0x3f553f80,0xbe483ec4,0xbf55bf80,0x3e48bec4
    .long 0xbf35258d,0xbf35bf80,0xbf352654,0xbf35bf80,0xbf0ebf80,0x3f7b3ec4,0x3f0e3f80,0xbf7bbec4
    .long 0x3f6da5d4,0xbec43f35,0x3f6da69f,0xbec43f35,0x3e483f80,0xbf0ebf6d,0xbe48bf80,0x3f0e3f6d
    .long 0xbf80260d,0x3f80a630,0xbf8026d4,0x3f80270d,0x3e48bf80,0xbf0e3f6d,0xbe483f80,0x3f0ebf6d
    .long 0x3f6da630,0xbec4bf35,0x3f6da7c2,0xbec4bf35,0xbf0e3f80,0x3f7bbec4,0x3f0ebf80,0xbf7b3ec4
    .long 0xbf352654,0xbf353f80,0xbf35271f,0xbf353f80,0x3f55bf80,0xbe48bec4,0xbf553f80,0x3e483ec4
    .long 0x3ec4a677,0x3f6dbf35,0x3ec4268d,0x3f6dbf35,0xbf7b3f80,0xbf553f6d,0x3f7bbf80,0x3f55bf6d
    .long 0xbf803f80,0xbf803f80,0xbf803f80,0xbf803f80,0xbf0ebf35,0xbe48bec4,0x3f0e3f35,0x3e483ec4
    .long 0x3f6d3f80,0x3ec43f35,0x3f6d3f80,0x3ec43f35,0xbf7bbf35,0xbf0ebf6d,0x3f7b3f35,0x3f0e3f6d
    .long 0x3f35a5d4,0x3f353f80,0x3f35a677,0x3f353f80,0xbe483f35,0xbf55bf6d,0x3e48bf35,0x3f553f6d
    .long 0xbec4bf80,0x3f6d3f35,0xbec4bf80,0x3f6d3f35,0x3f553f35,0xbf7bbec4,0xbf55bf35,0x3f7b3ec4
    .long 0xbf802654,0x3f80a677,0xbf8026f7,0x3f80a7c2,0x3f55bf35,0xbf7b3ec4,0xbf553f35,0x3f7bbec4
    .long 0xbec43f80,0x3f6dbf35,0xbec43f80,0x3f6dbf35,0xbe48bf35,0xbf553f6d,0x3e483f35,0x3f55bf6d
    .long 0x3f35a69f,0x3f35bf80,0x3f35268d,0x3f35bf80,0xbf7b3f35,0xbf0e3f6d,0x3f7bbf35,0x3f0ebf6d
    .long 0x3f6dbf80,0x3ec4bf35,0x3f6dbf80,0x3ec4bf35,0xbf0e3f35,0xbe483ec4,0x3f0ebf35,0x3e48bec4
    .long 0x3f80,0x3f80,0x3f80,0x3f80,0x3f80,0x3ec43f6d,0x3f353f35,0x3f6d3ec4
    .long 0x3f80,0x3f353f35,0x3f80248d,0x3f35bf35,0x3f80,0x3f6d3ec4,0x3f35bf35,0xbec4bf6d
    .long 0x3f80,0x3f80248d,0x250dbf80,0xbf80a554,0x3f80,0x3f6dbec4,0xbf35bf35,0xbec43f6d
    .long 0x3f80,0x3f35bf35,0xbf80a554,0x3f353f35,0x3f80,0x3ec4bf6d,0xbf353f35,0x3f6dbec4
    .long 0x3f80,0x250dbf80,0xa58d3f80,0x25d4bf80,0x3f80,0xbec4bf6d,0x3f353f35,0xbf6dbec4
    .long 0x3f80,0xbf35bf35,0x3f8025b0,0xbf353f35,0x3f80,0xbf6dbec4,0x3f35bf35,0x3ec43f6d
    .long 0x3f80,0xbf80a554,0x25d4bf80,0x3f80261f,0x3f80,0xbf6d3ec4,0xbf35bf35,0x3ec4bf6d
    .long 0x3f80,0xbf353f35,0xbf80a5f7,0xbf35bf35,0x3f80,0xbec43f6d,0xbf353f35,0xbf6d3ec4
    .long 0x3f80,0x3f80,0x3f80,0x3f80,0x3f80248d,0x3f6dbec4,0x3f35bf35,0x3ec4bf6d
    .long 0x250dbf80,0xbf35bf35,0xbf80a554,0xbf353f35,0xbf80a554,0xbec43f6d,0x3f353f35,0x3f6dbec4
    .long 0xa58d3f80,0x3f8025b0,0x25d4bf80,0xbf80a5f7,0x3f8025b0,0xbec4bf6d,0xbf353f35,0x3f6d3ec4
    .long 0x25d4bf80,0xbf353f35,0x3f80261f,0xbf35bf35,0xbf80a5f7,0x3f6d3ec4,0xbf35bf35,0x3ec43f6d
    .long 0xa60d3f80,0x2630bf80,0xa6543f80,0x2677bf80,0x3f80261f,0xbf6d3ec4,0x3f35bf35,0xbec43f6d
    .long 0x2630bf80,0x3f353f35,0xbf80a742,0x3f35bf35,0xbf80a731,0x3ec4bf6d,0x3f353f35,0xbf6d3ec4
    .long 0xa6543f80,0xbf80a742,0x269fbf80,0x3f80a60d,0x3f80a68d,0x3ec43f6d,0xbf353f35,0xbf6dbec4
    .long 0x2677bf80,0x3f35bf35,0x3f80a60d,0x3f353f35,0xbf80a742,0xbf6dbec4,0xbf35bf35,0xbec4bf6d
    .long 0x3f80,0x3f80,0x3f80,0x3f80,0x250dbf80,0xbec4bf6d,0xbf35bf35,0xbf6dbec4
    .long 0xa58d3f80,0x3f353f35,0x3f8025b0,0x3f35bf35,0x25d4bf80,0xbf6dbec4,0xbf353f35,0x3ec43f6d
    .long 0xa60d3f80,0x3f80261f,0x2630bf80,0xbf80a731,0x2630bf80,0xbf6d3ec4,0x3f353f35,0x3ec4bf6d
    .long 0xa6543f80,0x3f35bf35,0xbf80a742,0x3f353f35,0x2677bf80,0xbec43f6d,0x3f35bf35,0xbf6d3ec4
    .long 0xa68d3f80,0x269fbf80,0xa6b03f80,0x27b1bf80,0x269fbf80,0x3ec43f6d,0xbf35bf35,0x3f6d3ec4
    .long 0xa6b03f80,0xbf35bf35,0x3f80a58e,0xbf353f35,0x27b1bf80,0x3f6d3ec4,0xbf353f35,0xbec4bf6d
    .long 0xa6d43f80,0xbf80a777,0x27c2bf80,0x3f802804,0xa70dbf80,0x3f6dbec4,0x3f353f35,0xbec43f6d
    .long 0xa6f73f80,0xbf353f35,0xbf80a78d,0xbf35bf35,0x27c2bf80,0x3ec4bf6d,0x3f35bf35,0x3f6dbec4
    .long 0x3f80,0x3f80,0x3f80,0x3f80,0xbf80a554,0xbf6d3ec4,0xbf353f35,0xbec43f6d
    .long 0x25d4bf80,0xbf35bf35,0xbf80a5f7,0xbf353f35,0x3f80261f,0x3ec4bf6d,0xbf35bf35,0xbf6d3ec4
    .long 0xa6543f80,0x3f80a68d,0x2677bf80,0xbf80a742,0xbf80a742,0x3ec43f6d,0x3f35bf35,0xbf6dbec4
    .long 0x269fbf80,0xbf353f35,0x3f80a60d,0xbf35bf35,0x3f80a60d,0xbf6dbec4,0x3f353f35,0xbec4bf6d
    .long 0xa6d43f80,0xa70dbf80,0xa6f73f80,0x27c2bf80,0xbf80a777,0x3f6dbec4,0xbf353f35,0x3ec4bf6d
    .long 0x27c2bf80,0x3f353f35,0xbf80a78d,0x3f35bf35,0x3f80258d,0xbec43f6d,0xbf35bf35,0x3f6dbec4
    .long 0xa71f3f80,0xbf802754,0xa68dbf80,0x3f802889,0xbf80a796,0xbec4bf6d,0x3f35bf35,0x3f6d3ec4
    .long 0xa68dbf80,0x3f35bf35,0x3f802816,0x3f353f35,0x3f80268d,0x3f6d3ec4,0x3f353f35,0x3ec43f6d
    .long 0x3f808000,0x3f808000,0x3f808000,0x3f808000,0x3f808000,0x3f6dbec4,0x3f35bf35,0x3ec4bf6d
    .long 0x3f808000,0x3f35bf35,0x248dbf80,0xbf35bf35,0x3f808000,0x3ec4bf6d,0xbf35bf35,0xbf6d3ec4
    .long 0x3f808000,0x248dbf80,0xbf80a50d,0xa5543f80,0x3f808000,0xbec4bf6d,0xbf353f35,0x3f6d3ec4
    .long 0x3f808000,0xbf35bf35,0xa5543f80,0x3f35bf35,0x3f808000,0xbf6dbec4,0x3f353f35,0xbec4bf6d
    .long 0xbf800000,0x3f80250d,0xbf80a58d,0x3f8025d4,0xbf800000,0x3f6dbec4,0xbf353f35,0x3ec4bf6d
    .long 0xbf800000,0x3f35bf35,0xa5b03f80,0xbf35bf35,0xbf800000,0x3ec4bf6d,0x3f353f35,0xbf6d3ec4
    .long 0xbf800000,0x2554bf80,0x3f8025d4,0xa61f3f80,0xbf800000,0xbec4bf6d,0x3f35bf35,0x3f6d3ec4
    .long 0xbf800000,0xbf35bf35,0x25f7bf80,0x3f35bf35,0xbf800000,0xbf6dbec4,0xbf35bf35,0xbec4bf6d
    .long 0x3f808000,0x3f808000,0x3f808000,0x3f808000,0x248dbf80,0xbec4bf6d,0xbf35bf35,0xbf6dbec4
    .long 0xbf80a50d,0xbf353f35,0xa5543f80,0x3f353f35,0xa5543f80,0x3f6d3ec4,0x3f35bf35,0xbec4bf6d
    .long 0x3f80258d,0x25b0bf80,0xbf80a5d4,0xa5f73f80,0x25b0bf80,0xbf6d3ec4,0x3f353f35,0x3ec4bf6d
    .long 0xbf80a5d4,0x3f353f35,0x261fbf80,0xbf353f35,0xa5f73f80,0x3ec4bf6d,0xbf353f35,0x3f6dbec4
    .long 0xbf80a60d,0x3f802630,0xbf80a654,0x3f802677,0xa61f3f80,0xbec4bf6d,0x3f353f35,0xbf6dbec4
    .long 0x3f802630,0xbf353f35,0x2742bf80,0x3f353f35,0x2731bf80,0x3f6d3ec4,0xbf353f35,0xbec4bf6d
    .long 0xbf80a654,0x2742bf80,0x3f80269f,0x260d3f80,0x268d3f80,0xbf6d3ec4,0xbf35bf35,0x3ec4bf6d
    .long 0x3f802677,0x3f353f35,0x260d3f80,0xbf353f35,0x2742bf80,0x3ec4bf6d,0x3f35bf35,0x3f6dbec4
    .long 0x3f808000,0x3f808000,0x3f808000,0x3f808000,0xbf80a50d,0xbf6d3ec4,0xbf353f35,0xbec43f6d
    .long 0x3f80258d,0x3f35bf35,0x25b0bf80,0xbf35bf35,0xbf80a5d4,0xbec43f6d,0x3f353f35,0x3f6dbec4
    .long 0x3f80260d,0x261fbf80,0xbf80a630,0xa7313f80,0xbf80a630,0x3ec43f6d,0x3f35bf35,0xbf6dbec4
    .long 0x3f802654,0xbf35bf35,0xa7423f80,0x3f35bf35,0xbf80a677,0x3f6d3ec4,0xbf35bf35,0x3ec43f6d
    .long 0xbf80a68d,0x3f80269f,0xbf80a6b0,0x3f8027b1,0x3f80269f,0xbf6d3ec4,0x3f35bf35,0xbec43f6d
    .long 0xbf80a6b0,0x3f35bf35,0x258e3f80,0xbf35bf35,0x3f8027b1,0xbec43f6d,0xbf35bf35,0x3f6dbec4
    .long 0xbf80a6d4,0x2777bf80,0x3f8027c2,0xa8043f80,0x3f80a70d,0x3ec43f6d,0xbf353f35,0xbf6dbec4
    .long 0xbf80a6f7,0xbf35bf35,0x278dbf80,0x3f35bf35,0x3f8027c2,0x3f6d3ec4,0x3f353f35,0x3ec43f6d
    .long 0x3f808000,0x3f808000,0x3f808000,0x3f808000,0xa5543f80,0x3ec43f6d,0x3f353f35,0x3f6d3ec4
    .long 0xbf80a5d4,0xbf353f35,0xa5f73f80,0x3f353f35,0x261fbf80,0xbf6dbec4,0xbf353f35,0x3ec43f6d
    .long 0x3f802654,0xa68dbf80,0xbf80a677,0xa7423f80,0xa7423f80,0x3f6dbec4,0xbf35bf35,0xbec43f6d
    .long 0xbf80a69f,0x3f353f35,0xa60dbf80,0xbf353f35,0xa60dbf80,0xbec43f6d,0x3f35bf35,0xbf6d3ec4
    .long 0xbf80a6d4,0x3f80a70d,0xbf80a6f7,0x3f8027c2,0x2777bf80,0x3ec43f6d,0xbf35bf35,0x3f6d3ec4
    .long 0x3f8027c2,0xbf353f35,0x278dbf80,0x3f353f35,0xa58d3f80,0xbf6dbec4,0x3f35bf35,0x3ec43f6d
    .long 0xbf80a71f,0xa754bf80,0x3f80a68d,0xa8893f80,0x2796bf80,0x3f6dbec4,0x3f353f35,0xbec43f6d
    .long 0x3f80a68d,0x3f353f35,0xa8163f80,0xbf353f35,0xa68d3f80,0xbec43f6d,0xbf353f35,0xbf6d3ec4
    .long 0x3f80,0xbf80,0x3f80,0xbf80,0x3f80,0x3f6d,0x3f35,0x3ec4
    .long 0x3f80,0x3f35,0x248d,0xbf35,0x3f80,0x3ec4,0xbf35,0xbf6d
    .long 0x3f80,0x248d,0xbf80,0xa554,0x3f80,0xbec4,0xbf35,0x3f6d
    .long 0x3f80,0xbf35,0xa554,0x3f35,0x3f80,0xbf6d,0x3f35,0xbec4
    .long 0x3f800000,0x3f7b0000,0x3f6d0000,0x3f550000,0x3f800000,0x3f550000,0x3ec40000,0xbe480000
    .long 0x3f800000,0x3f0e0000,0xbec40000,0xbf7b0000,0x3f800000,0x3e480000,0xbf6d0000,0xbf0e0000
    .long 0x3f800000,0xbe480000,0xbf6d0000,0x3f0e0000,0x3f800000,0xbf0e0000,0xbec40000,0x3f7b0000
    .long 0x3f800000,0xbf550000,0x3ec40000,0x3e480000,0x3f800000,0xbf7b0000,0x3f6d0000,0xbf550000
    .long 0x3f80,0xbf80,0x3f80,0xbf80,0x248d,0xbec4,0xbf35,0xbf6d
    .long 0xbf80,0xbf35,0xa554,0x3f35,0xa554,0x3f6d,0x3f35,0xbec4
    .long 0x3f80,0x25b0,0xbf80,0xa5f7,0x25b0,0xbf6d,0x3f35,0x3ec4
    .long 0xbf80,0x3f35,0x261f,0xbf35,0xa5f7,0x3ec4,0xbf35,0x3f6d
    .long 0x3f350000,0x3f0e0000,0x3ec40000,0x3e480000,0xbf350000,0xbf7b0000,0xbf6d0000,0xbf0e0000
    .long 0xbf350000,0x3e480000,0x3f6d0000,0x3f550000,0x3f350000,0x3f550000,0xbec40000,0xbf7b0000
    .long 0x3f350000,0xbf550000,0xbec40000,0x3f7b0000,0xbf350000,0xbe480000,0x3f6d0000,0xbf550000
    .long 0xbf350000,0x3f7b0000,0xbf6d0000,0x3f0e0000,0x3f350000,0xbf0e0000,0x3ec40000,0xbe480000
    .long 0x3f80,0xbf80,0x3f80,0xbf80,0xbf80,0xbf6d,0xbf35,0xbec4
    .long 0x3f80,0x3f35,0x25b0,0xbf35,0xbf80,0xbec4,0x3f35,0x3f6d
    .long 0x3f80,0x261f,0xbf80,0xa731,0xbf80,0x3ec4,0x3f35,0xbf6d
    .long 0x3f80,0xbf35,0xa742,0x3f35,0xbf80,0x3f6d,0xbf35,0x3ec4
    .long 0x248d0000,0xbe480000,0xbec40000,0xbf0e0000,0xa5540000,0x3f0e0000,0x3f6d0000,0x3f7b0000
    .long 0x25b00000,0xbf550000,0xbf6d0000,0xbe480000,0xa5f70000,0x3f7b0000,0x3ec40000,0xbf550000
    .long 0x261f0000,0xbf7b0000,0x3ec40000,0x3f550000,0xa7310000,0x3f550000,0xbf6d0000,0x3e480000
    .long 0xa68d0000,0xbf0e0000,0x3f6d0000,0xbf7b0000,0xa7420000,0x3e480000,0xbec40000,0x3f0e0000
    .long 0x3f80,0xbf80,0x3f80,0xbf80,0xa554,0x3ec4,0x3f35,0x3f6d
    .long 0xbf80,0xbf35,0xa5f7,0x3f35,0x261f,0xbf6d,0xbf35,0x3ec4
    .long 0x3f80,0xa68d,0xbf80,0xa742,0xa742,0x3f6d,0xbf35,0xbec4
    .long 0xbf80,0x3f35,0xa60d,0xbf35,0xa60d,0xbec4,0x3f35,0xbf6d
    .long 0xbf350000,0xbf550000,0xbf6d0000,0xbf7b0000,0x3f350000,0x3e480000,0xbec40000,0xbf550000
    .long 0x3f350000,0x3f7b0000,0x3ec40000,0xbf0e0000,0xbf350000,0x3f0e0000,0x3f6d0000,0xbe480000
    .long 0xbf350000,0xbf0e0000,0x3f6d0000,0x3e480000,0x3f350000,0xbf7b0000,0x3ec40000,0x3f0e0000
    .long 0x3f350000,0xbe480000,0xbec40000,0x3f550000,0xbf350000,0x3f550000,0xbf6d0000,0x3f7b0000
    .long 0x3b00,0x3b00,0x3b00,0x3b00,0x8000,0xbec4,0xbf35,0xbf6d
    .long 0x8000,0xbf35,0xbf80,0xbf35,0x8000,0xbf6d,0xbf35,0x3ec4
    .long 0x8000,0xbf80,0xa50d,0x3f80,0x8000,0xbf6d,0x3f35,0x3ec4
    .long 0x8000,0xbf35,0x3f80,0xbf35,0x8000,0xbec4,0x3f35,0xbf6d
    .long 0x80000000,0xbe480000,0xbec40000,0xbf0e0000,0x80000000,0xbf0e0000,0xbf6d0000,0xbf7b0000
    .long 0x80000000,0xbf550000,0xbf6d0000,0xbe480000,0x80000000,0xbf7b0000,0xbec40000,0x3f550000
    .long 0x80000000,0xbf7b0000,0x3ec40000,0x3f550000,0x80000000,0xbf550000,0x3f6d0000,0xbe480000
    .long 0x80000000,0xbf0e0000,0x3f6d0000,0xbf7b0000,0x80000000,0xbe480000,0x3ec40000,0xbf0e0000
    .long 0x3b00,0x3b00,0x3b00,0x3b00,0xbf80,0xbf6d,0xbf35,0xbec4
    .long 0xa50d,0x3f35,0x3f80,0x3f35,0x3f80,0x3ec4,0xbf35,0xbf6d
    .long 0x258d,0xbf80,0xa5d4,0x3f80,0xbf80,0x3ec4,0x3f35,0xbf6d
    .long 0xa5d4,0x3f35,0xbf80,0x3f35,0x3f80,0xbf6d,0x3f35,0xbec4
    .long 0xbf350000,0xbf550000,0xbf6d0000,0xbf7b0000,0xbf350000,0xbe480000,0x3ec40000,0x3f550000
    .long 0x3f350000,0x3f7b0000,0x3ec40000,0xbf0e0000,0x3f350000,0xbf0e0000,0xbf6d0000,0x3e480000
    .long 0xbf350000,0xbf0e0000,0x3f6d0000,0x3e480000,0xbf350000,0x3f7b0000,0xbec40000,0xbf0e0000
    .long 0x3f350000,0xbe480000,0xbec40000,0x3f550000,0x3f350000,0xbf550000,0x3f6d0000,0xbf7b0000
    .long 0x3b00,0x3b00,0x3b00,0x3b00,0xa50d,0x3ec4,0x3f35,0x3f6d
    .long 0x258d,0xbf35,0xbf80,0xbf35,0xa5d4,0x3f6d,0x3f35,0xbec4
    .long 0x260d,0xbf80,0xa630,0x3f80,0xa630,0x3f6d,0xbf35,0xbec4
    .long 0x2654,0xbf35,0x3f80,0xbf35,0xa677,0x3ec4,0xbf35,0x3f6d
    .long 0xbf800000,0xbf7b0000,0xbf6d0000,0xbf550000,0x3f800000,0x3f550000,0x3ec40000,0xbe480000
    .long 0xbf800000,0xbf0e0000,0x3ec40000,0x3f7b0000,0x3f800000,0x3e480000,0xbf6d0000,0xbf0e0000
    .long 0xbf800000,0x3e480000,0x3f6d0000,0xbf0e0000,0x3f800000,0xbf0e0000,0xbec40000,0x3f7b0000
    .long 0xbf800000,0x3f550000,0xbec40000,0xbe480000,0x3f800000,0xbf7b0000,0x3f6d0000,0xbf550000
    .long 0x3b00,0x3b00,0x3b00,0x3b00,0x3f80,0x3f6d,0x3f35,0x3ec4
    .long 0xa5d4,0x3f35,0x3f80,0x3f35,0xbf80,0xbec4,0x3f35,0x3f6d
    .long 0x2654,0xbf80,0xa677,0x3f80,0x3f80,0xbec4,0xbf35,0x3f6d
    .long 0xa69f,0x3f35,0xbf80,0x3f35,0xbf80,0x3f6d,0xbf35,0x3ec4
    .long 0xbf350000,0xbf0e0000,0xbec40000,0xbe480000,0xbf350000,0xbf7b0000,0xbf6d0000,0xbf0e0000
    .long 0x3f350000,0xbe480000,0xbf6d0000,0xbf550000,0x3f350000,0x3f550000,0xbec40000,0xbf7b0000
    .long 0xbf350000,0x3f550000,0x3ec40000,0xbf7b0000,0xbf350000,0xbe480000,0x3f6d0000,0xbf550000
    .long 0x3f350000,0xbf7b0000,0x3f6d0000,0xbf0e0000,0x3f350000,0xbf0e0000,0x3ec40000,0xbe480000
    .long 0x3f80,0x3f80,0x3f80,0x3f80,0x3f80,0x3ec43f6d,0x3f353f35,0x3f6d3ec4
    .long 0x3f80,0x3f353f35,0x3f80248d,0x3f35bf35,0x3f80,0x3f6d3ec4,0x3f35bf35,0xbec4bf6d
    .long 0x3f80,0x3f80248d,0x250dbf80,0xbf80a554,0x3f80,0x3f6dbec4,0xbf35bf35,0xbec43f6d
    .long 0x3f80,0x3f35bf35,0xbf80a554,0x3f353f35,0x3f80,0x3ec4bf6d,0xbf353f35,0x3f6dbec4
    .long 0x3f80,0x250dbf80,0xa58d3f80,0x25d4bf80,0x3f80,0xbec4bf6d,0x3f353f35,0xbf6dbec4
    .long 0x3f80,0xbf35bf35,0x3f8025b0,0xbf353f35,0x3f80,0xbf6dbec4,0x3f35bf35,0x3ec43f6d
    .long 0x3f80,0xbf80a554,0x25d4bf80,0x3f80261f,0x3f80,0xbf6d3ec4,0xbf35bf35,0x3ec4bf6d
    .long 0x3f80,0xbf353f35,0xbf80a5f7,0xbf35bf35,0x3f80,0xbec43f6d,0xbf353f35,0xbf6d3ec4
    .long 0x3f80,0x3f80,0x3f80,0x3f80,0x3f80248d,0x3f6dbec4,0x3f35bf35,0x3ec4bf6d
    .long 0x250dbf80,0xbf35bf35,0xbf80a554,0xbf353f35,0xbf80a554,0xbec43f6d,0x3f353f35,0x3f6dbec4
    .long 0xa58d3f80,0x3f8025b0,0x25d4bf80,0xbf80a5f7,0x3f8025b0,0xbec4bf6d,0xbf353f35,0x3f6d3ec4
    .long 0x25d4bf80,0xbf353f35,0x3f80261f,0xbf35bf35,0xbf80a5f7,0x3f6d3ec4,0xbf35bf35,0x3ec43f6d
    .long 0xa60d3f80,0x2630bf80,0xa6543f80,0x2677bf80,0x3f80261f,0xbf6d3ec4,0x3f35bf35,0xbec43f6d
    .long 0x2630bf80,0x3f353f35,0xbf80a742,0x3f35bf35,0xbf80a731,0x3ec4bf6d,0x3f353f35,0xbf6d3ec4
    .long 0xa6543f80,0xbf80a742,0x269fbf80,0x3f80a60d,0x3f80a68d,0x3ec43f6d,0xbf353f35,0xbf6dbec4
    .long 0x2677bf80,0x3f35bf35,0x3f80a60d,0x3f353f35,0xbf80a742,0xbf6dbec4,0xbf35bf35,0xbec4bf6d
    .long 0x3f80,0x3f80,0x3f80,0x3f80,0x250dbf80,0xbec4bf6d,0xbf35bf35,0xbf6dbec4
    .long 0xa58d3f80,0x3f353f35,0x3f8025b0,0x3f35bf35,0x25d4bf80,0xbf6dbec4,0xbf353f35,0x3ec43f6d
    .long 0xa60d3f80,0x3f80261f,0x2630bf80,0xbf80a731,0x2630bf80,0xbf6d3ec4,0x3f353f35,0x3ec4bf6d
    .long 0xa6543f80,0x3f35bf35,0xbf80a742,0x3f353f35,0x2677bf80,0xbec43f6d,0x3f35bf35,0xbf6d3ec4
    .long 0xa68d3f80,0x269fbf80,0xa6b03f80,0x27b1bf80,0x269fbf80,0x3ec43f6d,0xbf35bf35,0x3f6d3ec4
    .long 0xa6b03f80,0xbf35bf35,0x3f80a58e,0xbf353f35,0x27b1bf80,0x3f6d3ec4,0xbf353f35,0xbec4bf6d
    .long 0xa6d43f80,0xbf80a777,0x27c2bf80,0x3f80258d,0xa70dbf80,0x3f6dbec4,0x3f353f35,0xbec43f6d
    .long 0xa6f73f80,0xbf353f35,0xbf80a78d,0xbf35bf35,0x27c2bf80,0x3ec4bf6d,0x3f35bf35,0x3f6dbec4
    .long 0x3f80,0x3f80,0x3f80,0x3f80,0xbf80a554,0xbf6d3ec4,0xbf353f35,0xbec43f6d
    .long 0x25d4bf80,0xbf35bf35,0xbf80a5f7,0xbf353f35,0x3f80261f,0x3ec4bf6d,0xbf35bf35,0xbf6d3ec4
    .long 0xa6543f80,0x3f80a68d,0x2677bf80,0xbf80a742,0xbf80a742,0x3ec43f6d,0x3f35bf35,0xbf6dbec4
    .long 0x269fbf80,0xbf353f35,0x3f80a60d,0xbf35bf35,0x3f80a60d,0xbf6dbec4,0x3f353f35,0xbec4bf6d
    .long 0xa6d43f80,0xa70dbf80,0xa6f73f80,0x27c2bf80,0xbf80a777,0x3f6dbec4,0xbf353f35,0x3ec4bf6d
    .long 0x27c2bf80,0x3f353f35,0xbf80a78d,0x3f35bf35,0x3f802804,0xbec43f6d,0xbf35bf35,0x3f6dbec4
    .long 0xa71f3f80,0xbf80a796,0xa68dbf80,0x3f80268d,0xbf802754,0xbec4bf6d,0x3f35bf35,0x3f6d3ec4
    .long 0xa68dbf80,0x3f35bf35,0x3f802816,0x3f353f35,0x3f802889,0x3f6d3ec4,0x3f353f35,0x3ec43f6d
    .long 0x3f808000,0x3f808000,0x3f808000,0x3f808000,0x3f808000,0x3f6dbec4,0x3f35bf35,0x3ec4bf6d
    .long 0x3f808000,0x3f35bf35,0x248dbf80,0xbf35bf35,0x3f808000,0x3ec4bf6d,0xbf35bf35,0xbf6d3ec4
    .long 0x3f808000,0x248dbf80,0xbf80a50d,0xa5543f80,0x3f808000,0xbec4bf6d,0xbf353f35,0x3f6d3ec4
    .long 0x3f808000,0xbf35bf35,0xa5543f80,0x3f35bf35,0x3f808000,0xbf6dbec4,0x3f353f35,0xbec4bf6d
    .long 0x3f808000,0xbf80a50d,0x3f80258d,0xbf80a5d4,0x3f808000,0xbf6d3ec4,0x3f35bf35,0xbec43f6d
    .long 0x3f808000,0xbf353f35,0x25b0bf80,0x3f353f35,0x3f808000,0xbec43f6d,0xbf35bf35,0x3f6dbec4
    .long 0x3f808000,0xa5543f80,0xbf80a5d4,0x261fbf80,0x3f808000,0x3ec43f6d,0xbf353f35,0xbf6dbec4
    .long 0x3f808000,0x3f353f35,0xa5f73f80,0xbf353f35,0x3f808000,0x3f6d3ec4,0x3f353f35,0x3ec43f6d
    .long 0x3f808000,0x3f808000,0x3f808000,0x3f808000,0x248dbf80,0xbec4bf6d,0xbf35bf35,0xbf6dbec4
    .long 0xbf80a50d,0xbf353f35,0xa5543f80,0x3f353f35,0xa5543f80,0x3f6d3ec4,0x3f35bf35,0xbec4bf6d
    .long 0x3f80258d,0x25b0bf80,0xbf80a5d4,0xa5f73f80,0x25b0bf80,0xbf6d3ec4,0x3f353f35,0x3ec4bf6d
    .long 0xbf80a5d4,0x3f353f35,0x261fbf80,0xbf353f35,0xa5f73f80,0x3ec4bf6d,0xbf353f35,0x3f6dbec4
    .long 0x3f80260d,0xbf80a630,0x3f802654,0xbf80a677,0x261fbf80,0x3ec43f6d,0xbf35bf35,0x3f6d3ec4
    .long 0xbf80a630,0x3f35bf35,0xa7423f80,0xbf35bf35,0xa7313f80,0xbf6dbec4,0x3f35bf35,0x3ec43f6d
    .long 0x3f802654,0xa7423f80,0xbf80a69f,0xa60dbf80,0xa68dbf80,0x3f6dbec4,0x3f353f35,0xbec43f6d
    .long 0xbf80a677,0xbf35bf35,0xa60dbf80,0x3f35bf35,0xa7423f80,0xbec43f6d,0xbf353f35,0xbf6d3ec4
    .long 0x3f808000,0x3f808000,0x3f808000,0x3f808000,0xbf80a50d,0xbf6d3ec4,0xbf353f35,0xbec43f6d
    .long 0x3f80258d,0x3f35bf35,0x25b0bf80,0xbf35bf35,0xbf80a5d4,0xbec43f6d,0x3f353f35,0x3f6dbec4
    .long 0x3f80260d,0x261fbf80,0xbf80a630,0xa7313f80,0xbf80a630,0x3ec43f6d,0x3f35bf35,0xbf6dbec4
    .long 0x3f802654,0xbf35bf35,0xa7423f80,0x3f35bf35,0xbf80a677,0x3f6d3ec4,0xbf35bf35,0x3ec43f6d
    .long 0x3f80268d,0xbf80a69f,0x3f8026b0,0xbf80a7b1,0xbf80a69f,0x3f6dbec4,0xbf353f35,0x3ec4bf6d
    .long 0x3f8026b0,0xbf353f35,0xa58ebf80,0x3f353f35,0xbf80a7b1,0x3ec4bf6d,0x3f353f35,0xbf6d3ec4
    .long 0x3f8026d4,0xa7773f80,0xbf80a7c2,0x258dbf80,0xbf80270d,0xbec4bf6d,0x3f35bf35,0x3f6d3ec4
    .long 0x3f8026f7,0x3f353f35,0xa78d3f80,0xbf353f35,0xbf80a7c2,0xbf6dbec4,0xbf35bf35,0xbec4bf6d
    .long 0x3f808000,0x3f808000,0x3f808000,0x3f808000,0xa5543f80,0x3ec43f6d,0x3f353f35,0x3f6d3ec4
    .long 0xbf80a5d4,0xbf353f35,0xa5f73f80,0x3f353f35,0x261fbf80,0xbf6dbec4,0xbf353f35,0x3ec43f6d
    .long 0x3f802654,0xa68dbf80,0xbf80a677,0xa7423f80,0xa7423f80,0x3f6dbec4,0xbf35bf35,0xbec43f6d
    .long 0xbf80a69f,0x3f353f35,0xa60dbf80,0xbf353f35,0xa60dbf80,0xbec43f6d,0x3f35bf35,0xbf6d3ec4
    .long 0x3f8026d4,0xbf80270d,0x3f8026f7,0xbf80a7c2,0xa7773f80,0xbec4bf6d,0x3f353f35,0xbf6dbec4
    .long 0xbf80a7c2,0x3f35bf35,0xa78d3f80,0xbf35bf35,0x2804bf80,0x3f6d3ec4,0xbf353f35,0xbec4bf6d
    .long 0x3f80271f,0xa7963f80,0xbf80268d,0x268dbf80,0x27543f80,0xbf6d3ec4,0xbf35bf35,0x3ec4bf6d
    .long 0xbf80268d,0xbf35bf35,0x2816bf80,0x3f35bf35,0x2889bf80,0x3ec4bf6d,0x3f35bf35,0x3f6dbec4
    .long 0x80003f80,0x80003f80,0x80003f80,0x80003f80,0x80003f80,0xbec43f6d,0xbf353f35,0xbf6d3ec4
    .long 0x80003f80,0xbf353f35,0xbf80248d,0xbf35bf35,0x80003f80,0xbf6d3ec4,0xbf35bf35,0x3ec4bf6d
    .long 0x80003f80,0xbf80248d,0xa50dbf80,0x3f80a554,0x80003f80,0xbf6dbec4,0x3f35bf35,0x3ec43f6d
    .long 0x80003f80,0xbf35bf35,0x3f80a554,0xbf353f35,0x80003f80,0xbec4bf6d,0x3f353f35,0xbf6dbec4
    .long 0x80003f80,0xa50dbf80,0x258d3f80,0xa5d4bf80,0x80003f80,0x3ec4bf6d,0xbf353f35,0x3f6dbec4
    .long 0x80003f80,0x3f35bf35,0xbf8025b0,0x3f353f35,0x80003f80,0x3f6dbec4,0xbf35bf35,0xbec43f6d
    .long 0x80003f80,0x3f80a554,0xa5d4bf80,0xbf80261f,0x80003f80,0x3f6d3ec4,0x3f35bf35,0xbec4bf6d
    .long 0x80003f80,0x3f353f35,0x3f80a5f7,0x3f35bf35,0x80003f80,0x3ec43f6d,0x3f353f35,0x3f6d3ec4
    .long 0x80003f80,0x80003f80,0x80003f80,0x80003f80,0xbf80248d,0xbf6dbec4,0xbf35bf35,0xbec4bf6d
    .long 0xa50dbf80,0x3f35bf35,0x3f80a554,0x3f353f35,0x3f80a554,0x3ec43f6d,0xbf353f35,0xbf6dbec4
    .long 0x258d3f80,0xbf8025b0,0xa5d4bf80,0x3f80a5f7,0xbf8025b0,0x3ec4bf6d,0x3f353f35,0xbf6d3ec4
    .long 0xa5d4bf80,0x3f353f35,0xbf80261f,0x3f35bf35,0x3f80a5f7,0xbf6d3ec4,0x3f35bf35,0xbec43f6d
    .long 0x260d3f80,0xa630bf80,0x26543f80,0xa677bf80,0xbf80261f,0x3f6d3ec4,0xbf35bf35,0x3ec43f6d
    .long 0xa630bf80,0xbf353f35,0x3f80a742,0xbf35bf35,0x3f80a731,0xbec4bf6d,0xbf353f35,0x3f6d3ec4
    .long 0x26543f80,0x3f80a742,0xa69fbf80,0xbf80a60d,0xbf80a68d,0xbec43f6d,0x3f353f35,0x3f6dbec4
    .long 0xa677bf80,0xbf35bf35,0xbf80a60d,0xbf353f35,0x3f80a742,0x3f6dbec4,0x3f35bf35,0x3ec4bf6d
    .long 0x80003f80,0x80003f80,0x80003f80,0x80003f80,0xa50dbf80,0x3ec4bf6d,0x3f35bf35,0x3f6dbec4
    .long 0x258d3f80,0xbf353f35,0xbf8025b0,0xbf35bf35,0xa5d4bf80,0x3f6dbec4,0x3f353f35,0xbec43f6d
    .long 0x260d3f80,0xbf80261f,0xa630bf80,0x3f80a731,0xa630bf80,0x3f6d3ec4,0xbf353f35,0xbec4bf6d
    .long 0x26543f80,0xbf35bf35,0x3f80a742,0xbf353f35,0xa677bf80,0x3ec43f6d,0xbf35bf35,0x3f6d3ec4
    .long 0x268d3f80,0xa69fbf80,0x26b03f80,0xa7b1bf80,0xa69fbf80,0xbec43f6d,0x3f35bf35,0xbf6d3ec4
    .long 0x26b03f80,0x3f35bf35,0xbf80a58e,0x3f353f35,0xa7b1bf80,0xbf6d3ec4,0x3f353f35,0x3ec4bf6d
    .long 0x26d43f80,0x3f80a777,0xa7c2bf80,0xbf80258d,0x270dbf80,0xbf6dbec4,0xbf353f35,0x3ec43f6d
    .long 0x26f73f80,0x3f353f35,0x3f80a78d,0x3f35bf35,0xa7c2bf80,0xbec4bf6d,0xbf35bf35,0xbf6dbec4
    .long 0x80003f80,0x80003f80,0x80003f80,0x80003f80,0x3f80a554,0x3f6d3ec4,0x3f353f35,0x3ec43f6d
    .long 0xa5d4bf80,0x3f35bf35,0x3f80a5f7,0x3f353f35,0xbf80261f,0xbec4bf6d,0x3f35bf35,0x3f6d3ec4
    .long 0x26543f80,0xbf80a68d,0xa677bf80,0x3f80a742,0x3f80a742,0xbec43f6d,0xbf35bf35,0x3f6dbec4
    .long 0xa69fbf80,0x3f353f35,0xbf80a60d,0x3f35bf35,0xbf80a60d,0x3f6dbec4,0xbf353f35,0x3ec4bf6d
    .long 0x26d43f80,0x270dbf80,0x26f73f80,0xa7c2bf80,0x3f80a777,0xbf6dbec4,0x3f353f35,0xbec4bf6d
    .long 0xa7c2bf80,0xbf353f35,0x3f80a78d,0xbf35bf35,0xbf802804,0x3ec43f6d,0x3f35bf35,0xbf6dbec4
    .long 0x271f3f80,0x3f80a796,0x268dbf80,0xbf80268d,0x3f802754,0x3ec4bf6d,0xbf35bf35,0xbf6d3ec4
    .long 0x268dbf80,0xbf35bf35,0xbf802816,0xbf353f35,0xbf802889,0xbf6d3ec4,0xbf353f35,0xbec43f6d
    .long 0x3f800000,0x3f800000,0x3f800000,0x3f800000,0x3f800000,0x3f6d3ec4,0x3f353f35,0x3ec43f6d
    .long 0x3f800000,0x3f353f35,0x248d3f80,0xbf353f35,0x3f800000,0x3ec43f6d,0xbf353f35,0xbf6dbec4
    .long 0x3f800000,0x248d3f80,0xbf80250d,0xa554bf80,0x3f800000,0xbec43f6d,0xbf35bf35,0x3f6dbec4
    .long 0x3f800000,0xbf353f35,0xa554bf80,0x3f353f35,0x3f800000,0xbf6d3ec4,0x3f35bf35,0xbec43f6d
    .long 0x3f800000,0xbf80250d,0x3f80a58d,0xbf8025d4,0x3f800000,0xbf6dbec4,0x3f353f35,0xbec4bf6d
    .long 0x3f800000,0xbf35bf35,0x25b03f80,0x3f35bf35,0x3f800000,0xbec4bf6d,0xbf353f35,0x3f6d3ec4
    .long 0x3f800000,0xa554bf80,0xbf8025d4,0x261f3f80,0x3f800000,0x3ec4bf6d,0xbf35bf35,0xbf6d3ec4
    .long 0x3f800000,0x3f35bf35,0xa5f7bf80,0xbf35bf35,0x3f800000,0x3f6dbec4,0x3f35bf35,0x3ec4bf6d
    .long 0x3f800000,0x3f800000,0x3f800000,0x3f800000,0x248d3f80,0xbec43f6d,0xbf353f35,0xbf6d3ec4
    .long 0xbf80250d,0xbf35bf35,0xa554bf80,0x3f35bf35,0xa554bf80,0x3f6dbec4,0x3f353f35,0xbec43f6d
    .long 0x3f80a58d,0x25b03f80,0xbf8025d4,0xa5f7bf80,0x25b03f80,0xbf6dbec4,0x3f35bf35,0x3ec43f6d
    .long 0xbf8025d4,0x3f35bf35,0x261f3f80,0xbf35bf35,0xa5f7bf80,0x3ec43f6d,0xbf35bf35,0x3f6d3ec4
    .long 0x3f80a60d,0xbf802630,0x3f80a654,0xbf802677,0x261f3f80,0x3ec4bf6d,0xbf353f35,0x3f6dbec4
    .long 0xbf802630,0x3f353f35,0xa742bf80,0xbf353f35,0xa731bf80,0xbf6d3ec4,0x3f353f35,0x3ec4bf6d
    .long 0x3f80a654,0xa742bf80,0xbf80269f,0xa60d3f80,0xa68d3f80,0x3f6d3ec4,0x3f35bf35,0xbec4bf6d
    .long 0xbf802677,0xbf353f35,0xa60d3f80,0x3f353f35,0xa742bf80,0xbec4bf6d,0xbf35bf35,0xbf6dbec4
    .long 0x3f800000,0x3f800000,0x3f800000,0x3f800000,0xbf80250d,0xbf6dbec4,0xbf35bf35,0xbec4bf6d
    .long 0x3f80a58d,0x3f353f35,0x25b03f80,0xbf353f35,0xbf8025d4,0xbec4bf6d,0x3f35bf35,0x3f6d3ec4
    .long 0x3f80a60d,0x261f3f80,0xbf802630,0xa731bf80,0xbf802630,0x3ec4bf6d,0x3f353f35,0xbf6d3ec4
    .long 0x3f80a654,0xbf353f35,0xa742bf80,0x3f353f35,0xbf802677,0x3f6dbec4,0xbf353f35,0x3ec4bf6d
    .long 0x3f80a68d,0xbf80269f,0x3f80a6b0,0xbf8027b1,0xbf80269f,0x3f6d3ec4,0xbf35bf35,0x3ec43f6d
    .long 0x3f80a6b0,0xbf35bf35,0xa58e3f80,0x3f35bf35,0xbf8027b1,0x3ec43f6d,0x3f35bf35,0xbf6dbec4
    .long 0x3f80a6d4,0xa777bf80,0xbf8027c2,0x258d3f80,0xbf80a70d,0xbec43f6d,0x3f353f35,0x3f6dbec4
    .long 0x3f80a6f7,0x3f35bf35,0xa78dbf80,0xbf35bf35,0xbf8027c2,0xbf6d3ec4,0xbf353f35,0xbec43f6d
    .long 0x3f800000,0x3f800000,0x3f800000,0x3f800000,0xa554bf80,0x3ec4bf6d,0x3f35bf35,0x3f6dbec4
    .long 0xbf8025d4,0xbf35bf35,0xa5f7bf80,0x3f35bf35,0x261f3f80,0xbf6d3ec4,0xbf35bf35,0x3ec4bf6d
    .long 0x3f80a654,0xa68d3f80,0xbf802677,0xa742bf80,0xa742bf80,0x3f6d3ec4,0xbf353f35,0xbec4bf6d
    .long 0xbf80269f,0x3f35bf35,0xa60d3f80,0xbf35bf35,0xa60d3f80,0xbec4bf6d,0x3f353f35,0xbf6dbec4
    .long 0x3f80a6d4,0xbf80a70d,0x3f80a6f7,0xbf8027c2,0xa777bf80,0xbec43f6d,0x3f35bf35,0xbf6d3ec4
    .long 0xbf8027c2,0x3f353f35,0xa78dbf80,0xbf353f35,0x28043f80,0x3f6dbec4,0xbf35bf35,0xbec43f6d
    .long 0x3f80a71f,0xa796bf80,0xbf80a68d,0x268d3f80,0x2754bf80,0xbf6dbec4,0xbf353f35,0x3ec43f6d
    .long 0xbf80a68d,0xbf353f35,0x28163f80,0x3f353f35,0x28893f80,0x3ec43f6d,0x3f353f35,0x3f6d3ec4
    .long 0x80003f80,0x80003f80,0x80003f80,0x80003f80,0x80003f80,0xbec43f6d,0xbf353f35,0xbf6d3ec4
    .long 0x80003f80,0xbf353f35,0xbf80248d,0xbf35bf35,0x80003f80,0xbf6d3ec4,0xbf35bf35,0x3ec4bf6d
    .long 0x80003f80,0xbf80248d,0xa50dbf80,0x3f80a554,0x80003f80,0xbf6dbec4,0x3f35bf35,0x3ec43f6d
    .long 0x80003f80,0xbf35bf35,0x3f80a554,0xbf353f35,0x80003f80,0xbec4bf6d,0x3f353f35,0xbf6dbec4
    .long 0x80003f80,0xa50dbf80,0x258d3f80,0xa5d4bf80,0x80003f80,0x3ec4bf6d,0xbf353f35,0x3f6dbec4
    .long 0x80003f80,0x3f35bf35,0xbf8025b0,0x3f353f35,0x80003f80,0x3f6dbec4,0xbf35bf35,0xbec43f6d
    .long 0x80003f80,0x3f80a554,0xa5d4bf80,0xbf80261f,0x80003f80,0x3f6d3ec4,0x3f35bf35,0xbec4bf6d
    .long 0x80003f80,0x3f353f35,0x3f80a5f7,0x3f35bf35,0x80003f80,0x3ec43f6d,0x3f353f35,0x3f6d3ec4
    .long 0x80003f80,0x80003f80,0x80003f80,0x80003f80,0xbf80248d,0xbf6dbec4,0xbf35bf35,0xbec4bf6d
    .long 0xa50dbf80,0x3f35bf35,0x3f80a554,0x3f353f35,0x3f80a554,0x3ec43f6d,0xbf353f35,0xbf6dbec4
    .long 0x258d3f80,0xbf8025b0,0xa5d4bf80,0x3f80a5f7,0xbf8025b0,0x3ec4bf6d,0x3f353f35,0xbf6d3ec4
    .long 0xa5d4bf80,0x3f353f35,0xbf80261f,0x3f35bf35,0x3f80a5f7,0xbf6d3ec4,0x3f35bf35,0xbec43f6d
    .long 0x260d3f80,0xa630bf80,0x26543f80,0xa677bf80,0xbf80261f,0x3f6d3ec4,0xbf35bf35,0x3ec43f6d
    .long 0xa630bf80,0xbf353f35,0x3f80a742,0xbf35bf35,0x3f80a731,0xbec4bf6d,0xbf353f35,0x3f6d3ec4
    .long 0x26543f80,0x3f80a742,0xa69fbf80,0xbf80a60d,0xbf80a68d,0xbec43f6d,0x3f353f35,0x3f6dbec4
    .long 0xa677bf80,0xbf35bf35,0xbf80a60d,0xbf353f35,0x3f80a742,0x3f6dbec4,0x3f35bf35,0x3ec4bf6d
    .long 0x3f80,0x3f80,0x3f80,0x3f80,0x250dbf80,0xbec4bf6d,0xbf35bf35,0xbf6dbec4
    .long 0xa58d3f80,0x3f353f35,0x3f8025b0,0x3f35bf35,0x25d4bf80,0xbf6dbec4,0xbf353f35,0x3ec43f6d
    .long 0xa60d3f80,0x3f80261f,0x2630bf80,0xbf80a731,0x2630bf80,0xbf6d3ec4,0x3f353f35,0x3ec4bf6d
    .long 0xa6543f80,0x3f35bf35,0xbf80a742,0x3f353f35,0x2677bf80,0xbec43f6d,0x3f35bf35,0xbf6d3ec4
    .long 0xa68d3f80,0x269fbf80,0xa6b03f80,0x27b1bf80,0x269fbf80,0x3ec43f6d,0xbf35bf35,0x3f6d3ec4
    .long 0xa6b03f80,0xbf35bf35,0x3f80a58e,0xbf353f35,0x27b1bf80,0x3f6d3ec4,0xbf353f35,0xbec4bf6d
    .long 0xa6d43f80,0xbf80a777,0x27c2bf80,0x3f80258d,0xa70dbf80,0x3f6dbec4,0x3f353f35,0xbec43f6d
    .long 0xa6f73f80,0xbf353f35,0xbf80a78d,0xbf35bf35,0x27c2bf80,0x3ec4bf6d,0x3f35bf35,0x3f6dbec4
    .long 0x3f80,0x3f80,0x3f80,0x3f80,0xbf80a554,0xbf6d3ec4,0xbf353f35,0xbec43f6d
    .long 0x25d4bf80,0xbf35bf35,0xbf80a5f7,0xbf353f35,0x3f80261f,0x3ec4bf6d,0xbf35bf35,0xbf6d3ec4
    .long 0xa6543f80,0x3f80a68d,0x2677bf80,0xbf80a742,0xbf80a742,0x3ec43f6d,0x3f35bf35,0xbf6dbec4
    .long 0x269fbf80,0xbf353f35,0x3f80a60d,0xbf35bf35,0x3f80a60d,0xbf6dbec4,0x3f353f35,0xbec4bf6d
    .long 0xa6d43f80,0xa70dbf80,0xa6f73f80,0x27c2bf80,0xbf80a777,0x3f6dbec4,0xbf353f35,0x3ec4bf6d
    .long 0x27c2bf80,0x3f353f35,0xbf80a78d,0x3f35bf35,0x3f802804,0xbec43f6d,0xbf35bf35,0x3f6dbec4
    .long 0xa71f3f80,0xbf80a796,0xa68dbf80,0x3f80268d,0xbf802754,0xbec4bf6d,0x3f35bf35,0x3f6d3ec4
    .long 0xa68dbf80,0x3f35bf35,0x3f802816,0x3f353f35,0x3f802889,0x3f6d3ec4,0x3f353f35,0x3ec43f6d
    .long 0x3f800000,0x3f800000,0x3f800000,0x3f800000,0x3f800000,0x3f6d3ec4,0x3f353f35,0x3ec43f6d
    .long 0x3f800000,0x3f353f35,0x248d3f80,0xbf353f35,0x3f800000,0x3ec43f6d,0xbf353f35,0xbf6dbec4
    .long 0x3f800000,0x248d3f80,0xbf80250d,0xa554bf80,0x3f800000,0xbec43f6d,0xbf35bf35,0x3f6dbec4
    .long 0x3f800000,0xbf353f35,0xa554bf80,0x3f353f35,0x3f800000,0xbf6d3ec4,0x3f35bf35,0xbec43f6d
    .long 0x3f800000,0xbf80250d,0x3f80a58d,0xbf8025d4,0x3f800000,0xbf6dbec4,0x3f353f35,0xbec4bf6d
    .long 0x3f800000,0xbf35bf35,0x25b03f80,0x3f35bf35,0x3f800000,0xbec4bf6d,0xbf353f35,0x3f6d3ec4
    .long 0x3f800000,0xa554bf80,0xbf8025d4,0x261f3f80,0x3f800000,0x3ec4bf6d,0xbf35bf35,0xbf6d3ec4
    .long 0x3f800000,0x3f35bf35,0xa5f7bf80,0xbf35bf35,0x3f800000,0x3f6dbec4,0x3f35bf35,0x3ec4bf6d
    .long 0x3f800000,0x3f800000,0x3f800000,0x3f800000,0x248d3f80,0xbec43f6d,0xbf353f35,0xbf6d3ec4
    .long 0xbf80250d,0xbf35bf35,0xa554bf80,0x3f35bf35,0xa554bf80,0x3f6dbec4,0x3f353f35,0xbec43f6d
    .long 0x3f80a58d,0x25b03f80,0xbf8025d4,0xa5f7bf80,0x25b03f80,0xbf6dbec4,0x3f35bf35,0x3ec43f6d
    .long 0xbf8025d4,0x3f35bf35,0x261f3f80,0xbf35bf35,0xa5f7bf80,0x3ec43f6d,0xbf35bf35,0x3f6d3ec4
    .long 0x3f80a60d,0xbf802630,0x3f80a654,0xbf802677,0x261f3f80,0x3ec4bf6d,0xbf353f35,0x3f6dbec4
    .long 0xbf802630,0x3f353f35,0xa742bf80,0xbf353f35,0xa731bf80,0xbf6d3ec4,0x3f353f35,0x3ec4bf6d
    .long 0x3f80a654,0xa742bf80,0xbf80269f,0xa60d3f80,0xa68d3f80,0x3f6d3ec4,0x3f35bf35,0xbec4bf6d
    .long 0xbf802677,0xbf353f35,0xa60d3f80,0x3f353f35,0xa742bf80,0xbec4bf6d,0xbf35bf35,0xbf6dbec4
    .long 0xbf800000,0xbf800000,0xbf800000,0xbf800000,0x3f80250d,0x3f6dbec4,0x3f35bf35,0x3ec4bf6d
    .long 0xbf80a58d,0xbf353f35,0xa5b03f80,0x3f353f35,0x3f8025d4,0x3ec4bf6d,0xbf35bf35,0xbf6d3ec4
    .long 0xbf80a60d,0xa61f3f80,0x3f802630,0x2731bf80,0x3f802630,0xbec4bf6d,0xbf353f35,0x3f6d3ec4
    .long 0xbf80a654,0x3f353f35,0x2742bf80,0xbf353f35,0x3f802677,0xbf6dbec4,0x3f353f35,0xbec4bf6d
    .long 0xbf80a68d,0x3f80269f,0xbf80a6b0,0x3f8027b1,0x3f80269f,0xbf6d3ec4,0x3f35bf35,0xbec43f6d
    .long 0xbf80a6b0,0x3f35bf35,0x258e3f80,0xbf35bf35,0x3f8027b1,0xbec43f6d,0xbf35bf35,0x3f6dbec4
    .long 0xbf80a6d4,0x2777bf80,0x3f8027c2,0xa58d3f80,0x3f80a70d,0x3ec43f6d,0xbf353f35,0xbf6dbec4
    .long 0xbf80a6f7,0xbf35bf35,0x278dbf80,0x3f35bf35,0x3f8027c2,0x3f6d3ec4,0x3f353f35,0x3ec43f6d
    .long 0xbf800000,0xbf800000,0xbf800000,0xbf800000,0x2554bf80,0xbec4bf6d,0xbf35bf35,0xbf6dbec4
    .long 0x3f8025d4,0x3f35bf35,0x25f7bf80,0xbf35bf35,0xa61f3f80,0x3f6d3ec4,0x3f35bf35,0xbec4bf6d
    .long 0xbf80a654,0x268d3f80,0x3f802677,0x2742bf80,0x2742bf80,0xbf6d3ec4,0x3f353f35,0x3ec4bf6d
    .long 0x3f80269f,0xbf35bf35,0x260d3f80,0x3f35bf35,0x260d3f80,0x3ec4bf6d,0xbf353f35,0x3f6dbec4
    .long 0xbf80a6d4,0x3f80a70d,0xbf80a6f7,0x3f8027c2,0x2777bf80,0x3ec43f6d,0xbf35bf35,0x3f6d3ec4
    .long 0x3f8027c2,0xbf353f35,0x278dbf80,0x3f353f35,0xa8043f80,0xbf6dbec4,0x3f35bf35,0x3ec43f6d
    .long 0xbf80a71f,0x2796bf80,0x3f80a68d,0xa68d3f80,0xa754bf80,0x3f6dbec4,0x3f353f35,0xbec43f6d
    .long 0x3f80a68d,0x3f353f35,0xa8163f80,0xbf353f35,0xa8893f80,0xbec43f6d,0xbf353f35,0xbf6d3ec4
    .long 0x3f00,0x80003f80,0x80003f80,0x80003f80,0xbf00,0xbec43f6d,0xbf353f35,0xbf6d3ec4
    .long 0x3f00,0xbf353f35,0xbf80248d,0xbf35bf35,0xbf00,0xbf6d3ec4,0xbf35bf35,0x3ec4bf6d
    .long 0x3f00,0xbf80248d,0xa50dbf80,0x3f80a554,0xbf00,0xbf6dbec4,0x3f35bf35,0x3ec43f6d
    .long 0x3f00,0xbf35bf35,0x3f80a554,0xbf353f35,0xbf00,0xbec4bf6d,0x3f353f35,0xbf6dbec4
    .long 0x3f00,0xa50dbf80,0x258d3f80,0xa5d4bf80,0xbf00,0x3ec4bf6d,0xbf353f35,0x3f6dbec4
    .long 0x3f00,0x3f35bf35,0xbf8025b0,0x3f353f35,0xbf00,0x3f6dbec4,0xbf35bf35,0xbec43f6d
    .long 0x3f00,0x3f80a554,0xa5d4bf80,0xbf80261f,0xbf00,0x3f6d3ec4,0x3f35bf35,0xbec4bf6d
    .long 0x3f00,0x3f353f35,0x3f80a5f7,0x3f35bf35,0xbf00,0x3ec43f6d,0x3f353f35,0x3f6d3ec4
    .long 0x80003f80,0x80003f80,0x80003f80,0x80003f80,0xbf80248d,0xbf6dbec4,0xbf35bf35,0xbec4bf6d
    .long 0xa50dbf80,0x3f35bf35,0x3f80a554,0x3f353f35,0x3f80a554,0x3ec43f6d,0xbf353f35,0xbf6dbec4
    .long 0x258d3f80,0xbf8025b0,0xa5d4bf80,0x3f80a5f7,0xbf8025b0,0x3ec4bf6d,0x3f353f35,0xbf6d3ec4
    .long 0xa5d4bf80,0x3f353f35,0xbf80261f,0x3f35bf35,0x3f80a5f7,0xbf6d3ec4,0x3f35bf35,0xbec43f6d
    .long 0x260d3f80,0xa630bf80,0x26543f80,0xa677bf80,0xbf80261f,0x3f6d3ec4,0xbf35bf35,0x3ec43f6d
    .long 0xa630bf80,0xbf353f35,0x3f80a742,0xbf35bf35,0x3f80a731,0xbec4bf6d,0xbf353f35,0x3f6d3ec4
    .long 0x26543f80,0x3f80a742,0xa69fbf80,0xbf80a60d,0xbf80a68d,0xbec43f6d,0x3f353f35,0x3f6dbec4
    .long 0xa677bf80,0xbf35bf35,0xbf80a60d,0xbf353f35,0x3f80a742,0x3f6dbec4,0x3f35bf35,0x3ec4bf6d
    .long 0x0,0x0,0x0,0x0,0x0,0x0,0x0,0x0
    .long 0x0,0x0,0x0,0x0,0x0,0x0,0x0,0x0
    .long 0x0,0x0,0x0,0x0,0x0,0x0,0x0,0x0
    .long 0x0,0x0,0x0,0x0,0x0,0x0,0x0,0x0
    .long 0x0,0x0,0x0,0x0,0x0,0x0,0x0,0x0
    .long 0x0,0x0,0x0,0x0,0x0,0x0,0x0,0x0
    .long 0x0,0x0,0x0,0x0,0x0,0x0,0x0,0x0
    .long 0x0,0x0,0x0,0x0,0x0,0x0,0x0,0x0
    .long 0x0,0x0,0x0,0x0,0x0,0x0,0x0,0x0
    .long 0x0,0x0,0x0,0x0,0x0,0x0,0x0,0x0
    .long 0x0,0x0,0x0,0x0,0x0,0x0,0x0,0x0
    .long 0x0,0x0,0x0,0x0,0x0,0x0,0x0,0x0
    .long 0x0,0x0,0x0,0x0,0x0,0x0,0x0,0x0
    .long 0x0,0x0,0x0,0x0,0x0,0x0,0x0,0x0
    .long 0x0,0x0,0x0,0x0,0x0,0x0,0x0,0x0
    .long 0x0,0x0,0x0,0x0,0x0,0x0,0x0,0x0
    .long 0x0,0x0,0x0,0x0,0x0,0x0,0x0,0x0
    .long 0x0,0x0,0x0,0x0,0x0,0x0,0x0,0x0
    .long 0x0,0x0,0x0,0x0,0x0,0x0,0x0,0x0
    .long 0x0,0x0,0x0,0x0,0x0,0x0,0x0,0x0
    .long 0x0,0x0,0x0,0x0,0x0,0x0,0x0,0x0
    .long 0x0,0x0,0x0,0x0,0x0,0x0,0x0,0x0
    .long 0x0,0x0,0x0,0x0,0x0,0x0,0x0,0x0
    .long 0x0,0x0,0x0,0x0,0x0,0x0,0x0,0x0
    .long 0x0,0x0,0x0,0x0,0x0,0x0,0x0,0x0
    .long 0x0,0x0,0x0,0x0,0x0,0x0,0x0,0x0
    .long 0x0,0x0,0x0,0x0,0x0,0x0,0x0,0x0
    .long 0x0,0x0,0x0,0x0,0x0,0x0,0x0,0x0
    .long 0x0,0x0,0x0,0x0,0x0,0x0,0x0,0x0
    .long 0x0,0x0,0x0,0x0,0x0,0x0,0x0,0x0
    .long 0x0,0x0,0x0,0x0,0x0,0x0,0x0,0x0
    .long 0x0,0x0,0x0,0x0,0x0,0x0,0x0,0x0
    .long 0x80003f80,0x80003f80,0x80003f80,0x80003f80,0xbe483f7b,0xbf0e3f55,0xbf553f0e,0xbf7b3e48
    .long 0xbec43f6d,0xbf6d3ec4,0xbf6dbec4,0xbec4bf6d,0xbf0e3f55,0xbf7bbe48,0xbe48bf7b,0x3f55bf0e
    .long 0xbf353f35,0xbf35bf35,0x3f35bf35,0x3f353f35,0xbf553f0e,0xbe48bf7b,0x3f7b3e48,0xbf0e3f55
    .long 0xbf6d3ec4,0x3ec4bf6d,0x3ec43f6d,0xbf6dbec4,0xbf7b3e48,0x3f55bf0e,0xbf0e3f55,0x3e48bf7b
    .long 0xbf80248d,0x3f80a554,0xbf8025b0,0x3f80a5f7,0xbf7bbe48,0x3f553f0e,0xbf0ebf55,0x3e483f7b
    .long 0xbf6dbec4,0x3ec43f6d,0x3ec4bf6d,0xbf6d3ec4,0xbf55bf0e,0xbe483f7b,0x3f7bbe48,0xbf0ebf55
    .long 0xbf35bf35,0xbf353f35,0x3f353f35,0x3f35bf35,0xbf0ebf55,0xbf7b3e48,0xbe483f7b,0x3f553f0e
    .long 0xbec4bf6d,0xbf6dbec4,0xbf6d3ec4,0xbec43f6d,0xbe48bf7b,0xbf0ebf55,0xbf55bf0e,0xbf7bbe48
    .long 0x80003f80,0x80003f80,0x80003f80,0x80003f80,0xbf7bbe48,0xbf55bf0e,0xbf0ebf55,0xbe48bf7b
    .long 0x3ec4bf6d,0x3f6dbec4,0x3f6d3ec4,0x3ec43f6d,0x3f553f0e,0xbe483f7b,0xbf7b3e48,0xbf0ebf55
    .long 0xbf353f35,0xbf35bf35,0x3f35bf35,0x3f353f35,0xbf0ebf55,0x3f7bbe48,0xbe483f7b,0xbf55bf0e
    .long 0x3f6dbec4,0xbec43f6d,0xbec4bf6d,0x3f6d3ec4,0x3e483f7b,0xbf0ebf55,0x3f553f0e,0xbf7bbe48
    .long 0xbf80261f,0x3f80a731,0xbf80a68d,0x3f80a742,0x3e48bf7b,0xbf0e3f55,0x3f55bf0e,0xbf7b3e48
    .long 0x3f6d3ec4,0xbec4bf6d,0xbec43f6d,0x3f6dbec4,0xbf0e3f55,0x3f7b3e48,0xbe48bf7b,0xbf553f0e
    .long 0xbf35bf35,0xbf353f35,0x3f353f35,0x3f35bf35,0x3f55bf0e,0xbe48bf7b,0xbf7bbe48,0xbf0e3f55
    .long 0x3ec43f6d,0x3f6d3ec4,0x3f6dbec4,0x3ec4bf6d,0xbf7b3e48,0xbf553f0e,0xbf0e3f55,0xbe483f7b
    .long 0x36003600,0x80003600,0x80003600,0x80003600,0xb6003600,0xb4c835fb,0xb54435ed,0xb58e35d5
    .long 0x36003600,0xb54435ed,0xb5b535b5,0xb5ed3544,0xb6003600,0xb58e35d5,0xb5ed3544,0xb5fbb4c8
    .long 0x36003600,0xb5b535b5,0xb6001b0d,0xb5b5b5b5,0xb6003600,0xb5d5358e,0xb5edb544,0xb4c8b5fb
    .long 0x36003600,0xb5ed3544,0xb5b5b5b5,0x3544b5ed,0xb6003600,0xb5fb34c8,0xb544b5ed,0x35d5b58e
    .long 0x36003600,0xb6001b0d,0x9b8db600,0x36009bd4,0xb6003600,0xb5fbb4c8,0x3544b5ed,0x35d5358e
    .long 0x36003600,0xb5edb544,0x35b5b5b5,0x354435ed,0xb6003600,0xb5d5b58e,0x35edb544,0xb4c835fb
    .long 0x36003600,0xb5b5b5b5,0x36009bd4,0xb5b535b5,0xb6003600,0xb58eb5d5,0x35ed3544,0xb5fb34c8
    .long 0x36003600,0xb544b5ed,0x35b535b5,0xb5edb544,0xb6003600,0xb4c8b5fb,0x354435ed,0xb58eb5d5
    .long 0x80003600,0x80003600,0x80003600,0x80003600,0xb5b535b5,0xb5d5358e,0xb5ed3544,0xb5fb34c8
    .long 0xb6001b0d,0xb5edb544,0xb5b5b5b5,0xb544b5ed,0xb5b5b5b5,0xb4c8b5fb,0x3544b5ed,0x35d5b58e
    .long 0x9b8db600,0x35b5b5b5,0x36009bd4,0x35b535b5,0x35b5b5b5,0x35fb34c8,0x354435ed,0xb58e35d5
    .long 0x36009bd4,0x354435ed,0xb5b535b5,0xb5edb544,0x35b535b5,0xb58e35d5,0xb5edb544,0x34c8b5fb
    .long 0x1c0d3600,0xb6001c30,0x9c54b600,0x36009c77,0xb5b535b5,0xb58eb5d5,0x35edb544,0x34c835fb
    .long 0xb6001c30,0x3544b5ed,0x35b535b5,0xb5ed3544,0xb5b5b5b5,0x35fbb4c8,0xb54435ed,0xb58eb5d5
    .long 0x9c54b600,0x35b535b5,0xb6001c9f,0x35b5b5b5,0x35b5b5b5,0xb4c835fb,0xb544b5ed,0x35d5358e
    .long 0x36009c77,0xb5ed3544,0x35b5b5b5,0xb54435ed,0x35b535b5,0xb5d5b58e,0x35ed3544,0xb5fbb4c8
    .long 0x80003600,0x80003600,0x80003600,0x80003600,0xb6001b0d,0xb5fbb4c8,0xb5edb544,0xb5d5b58e
    .long 0x9b8db600,0x3544b5ed,0x35b5b5b5,0x35edb544,0x36009bd4,0x35d5358e,0x354435ed,0xb4c835fb
    .long 0x1c0d3600,0xb5b535b5,0xb6001c30,0xb5b5b5b5,0xb6001c30,0xb58eb5d5,0x3544b5ed,0x35fbb4c8
    .long 0x9c54b600,0x35edb544,0x35b535b5,0xb54435ed,0x36009c77,0x34c835fb,0xb5ed3544,0xb58eb5d5
    .long 0x1c8d3600,0xb6001c9f,0x9cb0b600,0x36009db1,0xb6001c9f,0x34c8b5fb,0x35ed3544,0xb58e35d5
    .long 0x9cb0b600,0x35ed3544,0xb5b535b5,0xb544b5ed,0x36009db1,0xb58e35d5,0xb544b5ed,0x35fb34c8
    .long 0x1cd43600,0xb5b5b5b5,0x36009dc2,0xb5b535b5,0xb6009d0d,0x35d5b58e,0xb54435ed,0xb4c8b5fb
    .long 0x9cf7b600,0x354435ed,0xb5b5b5b5,0x35ed3544,0x36009dc2,0xb5fb34c8,0x35edb544,0xb5d5358e
    .long 0x80003600,0x80003600,0x80003600,0x80003600,0xb5b5b5b5,0xb58eb5d5,0xb544b5ed,0xb4c8b5fb
    .long 0x36009bd4,0x35ed3544,0x35b535b5,0x354435ed,0xb5b535b5,0xb5fb34c8,0xb5edb544,0xb58eb5d5
    .long 0x9c54b600,0x35b5b5b5,0x36009c77,0x35b535b5,0x35b535b5,0xb4c835fb,0xb5ed3544,0xb5d5b58e
    .long 0xb6001c9f,0xb544b5ed,0x35b5b5b5,0x35ed3544,0x35b5b5b5,0x35d5358e,0xb54435ed,0xb5fbb4c8
    .long 0x1cd43600,0xb6009d0d,0x9cf7b600,0x36009dc2,0xb5b5b5b5,0x35d5b58e,0x354435ed,0xb5fb34c8
    .long 0x36009dc2,0xb54435ed,0xb5b5b5b5,0x35edb544,0xb5b535b5,0xb4c8b5fb,0x35ed3544,0xb5d5358e
    .long 0x9d1fb600,0x35b535b5,0xb6009c8d,0x35b5b5b5,0x35b535b5,0xb5fbb4c8,0x35edb544,0xb58e35d5
    .long 0xb6009c8d,0x35edb544,0xb5b535b5,0x3544b5ed,0x35b5b5b5,0xb58e35d5,0x3544b5ed,0xb4c835fb
    .long 0x36003600,0x9b8db600,0x1c0d3600,0x9c54b600,0xb6003600,0x34c8b5fb,0xb54435ed,0x358eb5d5
    .long 0x36003600,0x3544b5ed,0xb5b535b5,0x35edb544,0xb6003600,0x358eb5d5,0xb5ed3544,0x35fb34c8
    .long 0x36003600,0x35b5b5b5,0xb6001c30,0x35b535b5,0xb6003600,0x35d5b58e,0xb5edb544,0x34c835fb
    .long 0x36003600,0x35edb544,0xb5b5b5b5,0xb54435ed,0xb6003600,0x35fbb4c8,0xb544b5ed,0xb5d5358e
    .long 0x36003600,0x36009bd4,0x9c54b600,0xb6001c9f,0xb6003600,0x35fb34c8,0x3544b5ed,0xb5d5b58e
    .long 0x36003600,0x35ed3544,0x35b5b5b5,0xb544b5ed,0xb6003600,0x35d5358e,0x35edb544,0x34c8b5fb
    .long 0x36003600,0x35b535b5,0x36009c77,0x35b5b5b5,0xb6003600,0x358e35d5,0x35ed3544,0x35fbb4c8
    .long 0x36003600,0x354435ed,0x35b535b5,0x35ed3544,0xb6003600,0x34c835fb,0x354435ed,0x358e35d5
    .long 0x1c8d3600,0x9cb0b600,0x1cd43600,0x9cf7b600,0xb5b535b5,0x35d5b58e,0xb5ed3544,0x35fbb4c8
    .long 0xb6001c9f,0x35ed3544,0xb5b5b5b5,0x354435ed,0xb5b5b5b5,0x34c835fb,0x3544b5ed,0xb5d5358e
    .long 0x9cb0b600,0xb5b535b5,0x36009dc2,0xb5b5b5b5,0x35b5b5b5,0xb5fbb4c8,0x354435ed,0x358eb5d5
    .long 0x36009db1,0xb544b5ed,0xb5b535b5,0x35ed3544,0x35b535b5,0x358eb5d5,0xb5edb544,0xb4c835fb
    .long 0x1cd43600,0x36009dc2,0x9d1fb600,0xb6009c8d,0xb5b535b5,0x358e35d5,0x35edb544,0xb4c8b5fb
    .long 0xb6009d0d,0xb54435ed,0x35b535b5,0x35edb544,0xb5b5b5b5,0xb5fb34c8,0xb54435ed,0x358e35d5
    .long 0x9cf7b600,0xb5b5b5b5,0xb6009c8d,0xb5b535b5,0x35b5b5b5,0x34c8b5fb,0xb544b5ed,0xb5d5b58e
    .long 0x36009dc2,0x35edb544,0x35b5b5b5,0x3544b5ed,0x35b535b5,0x35d5358e,0x35ed3544,0x35fb34c8
    .long 0x1d0d3600,0x9d1fb600,0x1d303600,0x9e31b600,0xb6009cd4,0x35fb34c8,0xb5edb544,0x35d5358e
    .long 0x9d1fb600,0xb54435ed,0x35b5b5b5,0xb5ed3544,0x36009dd4,0xb5d5b58e,0x354435ed,0x34c8b5fb
    .long 0x1d303600,0x35b5b5b5,0xb6009c0e,0x35b535b5,0xb6009c8d,0x358e35d5,0x3544b5ed,0xb5fb34c8
    .long 0x9e31b600,0xb5ed3544,0x35b535b5,0x3544b5ed,0x36009de5,0xb4c8b5fb,0xb5ed3544,0x358e35d5
    .long 0x1d543600,0x36009df7,0x9e42b600,0xb6001c0d,0xb6009c0e,0xb4c835fb,0x35ed3544,0x358eb5d5
    .long 0x1d8db600,0xb5edb544,0xb5b535b5,0x354435ed,0x36009df7,0x358eb5d5,0xb544b5ed,0xb5fbb4c8
    .long 0x1d773600,0x35b535b5,0x36009e0d,0x35b5b5b5,0xb60097b7,0xb5d5358e,0xb54435ed,0x34c835fb
    .long 0x9e42b600,0xb544b5ed,0xb5b5b5b5,0xb5edb544,0x36009e04,0x35fbb4c8,0x35edb544,0x35d5b58e
    .long 0x1d543600,0x1d8db600,0x1d773600,0x9e42b600,0xb5b5b5b5,0x358e35d5,0xb544b5ed,0x34c835fb
    .long 0x36009df7,0xb5edb544,0x35b535b5,0xb544b5ed,0xb5b535b5,0x35fbb4c8,0xb5edb544,0x358e35d5
    .long 0x9e42b600,0xb5b535b5,0x36009e0d,0xb5b5b5b5,0x35b535b5,0x34c8b5fb,0xb5ed3544,0x35d5358e
    .long 0xb6001e84,0x354435ed,0x35b5b5b5,0xb5edb544,0x35b5b5b5,0xb5d5b58e,0xb54435ed,0x35fb34c8
    .long 0x1d9f3600,0x36009e16,0x1d0db600,0xb6001d0d,0xb5b5b5b5,0xb5d5358e,0x354435ed,0x35fbb4c8
    .long 0x36001dd4,0x3544b5ed,0xb5b5b5b5,0xb5ed3544,0xb5b535b5,0x34c835fb,0x35ed3544,0x35d5b58e
    .long 0x1d0db600,0xb5b5b5b5,0xb6001e96,0xb5b535b5,0x35b535b5,0x35fb34c8,0x35edb544,0x358eb5d5
    .long 0xb6001f09,0xb5ed3544,0xb5b535b5,0xb54435ed,0x35b5b5b5,0x358eb5d5,0x3544b5ed,0x34c8b5fb
    .long 0x3f80,0x0,0x0,0x0,0x3f800000,0x0,0x0,0x0
    .long 0x0,0x3f80,0x0,0x0,0x0,0x3f800000,0x0,0x0
    .long 0x0,0x0,0x0,0x0,0x0,0x0,0x0,0x0
    .long 0x0,0x0,0x0,0x0,0x0,0x0,0x0,0x0
    .long 0x0,0x0,0x0,0x0,0x0,0x0,0x0,0x0
    .long 0x0,0x0,0x0,0x0,0x0,0x0,0x0,0x0
    .long 0x0,0x0,0x0,0x0,0x0,0x0,0x0,0x0
    .long 0x0,0x0,0x0,0x0,0x0,0x0,0x0,0x0
    .long 0x0,0x0,0x0,0x0,0x0,0x0,0x0,0x0
    .long 0x0,0x0,0x0,0x0,0x0,0x0,0x0,0x0
    .long 0x3f80,0x0,0x0,0x0,0x3f800000,0x0,0x0,0x0
    .long 0x0,0x3f80,0x0,0x0,0x0,0x3f800000,0x0,0x0
    .long 0x0,0x0,0x0,0x0,0x0,0x0,0x0,0x0
    .long 0x0,0x0,0x0,0x0,0x0,0x0,0x0,0x0
    .long 0x0,0x0,0x0,0x0,0x0,0x0,0x0,0x0
    .long 0x0,0x0,0x0,0x0,0x0,0x0,0x0,0x0
    .long 0x0,0x0,0x0,0x0,0x0,0x0,0x0,0x0
    .long 0x0,0x0,0x0,0x0,0x0,0x0,0x0,0x0
    .long 0x0,0x0,0x0,0x0,0x0,0x0,0x0,0x0
    .long 0x0,0x0,0x0,0x0,0x0,0x0,0x0,0x0
    .long 0x3f80,0x0,0x0,0x0,0x3f800000,0x0,0x0,0x0
    .long 0x0,0x3f80,0x0,0x0,0x0,0x3f800000,0x0,0x0
    .long 0x0,0x0,0x0,0x0,0x0,0x0,0x0,0x0
    .long 0x0,0x0,0x0,0x0,0x0,0x0,0x0,0x0
    .long 0x0,0x0,0x0,0x0,0x0,0x0,0x0,0x0
    .long 0x0,0x0,0x0,0x0,0x0,0x0,0x0,0x0
    .long 0x0,0x0,0x0,0x0,0x0,0x0,0x0,0x0
    .long 0x0,0x0,0x0,0x0,0x0,0x0,0x0,0x0
    .long 0x0,0x0,0x0,0x0,0x0,0x0,0x0,0x0
    .long 0x0,0x0,0x0,0x0,0x0,0x0,0x0,0x0
    .long 0x3f80,0x0,0x0,0x0,0x3f800000,0x0,0x0,0x0
    .long 0x0,0x3f80,0x0,0x0,0x0,0x3f800000,0x0,0x0
    .long 0x0,0x0,0x3f80,0x0,0x0,0x0,0x3f800000,0x0
    .long 0x0,0x0,0x0,0x3f80,0x0,0x0,0x0,0x3f800000
    .long 0x0,0x0,0x0,0x0,0x0,0x0,0x0,0x0
    .long 0x0,0x0,0x0,0x0,0x0,0x0,0x0,0x0
    .long 0x0,0x0,0x0,0x0,0x0,0x0,0x0,0x0
    .long 0x0,0x0,0x0,0x0,0x0,0x0,0x0,0x0
    .long 0x0,0x0,0x0,0x0,0x0,0x0,0x0,0x0
    .long 0x0,0x0,0x0,0x0,0x0,0x0,0x0,0x0
    .long 0x0,0x0,0x0,0x0,0x0,0x0,0x0,0x0
    .long 0x0,0x0,0x0,0x0,0x0,0x0,0x0,0x0
    .long 0x0,0x0,0x3f80,0x0,0x0,0x0,0x3f800000,0x0
    .long 0x0,0x0,0x0,0x3f80,0x0,0x0,0x0,0x3f800000
    .long 0x0,0x0,0x0,0x0,0x0,0x0,0x0,0x0
    .long 0x0,0x0,0x0,0x0,0x0,0x0,0x0,0x0
    .long 0x0,0x0,0x0,0x0,0x0,0x0,0x0,0x0
    .long 0x0,0x0,0x0,0x0,0x0,0x0,0x0,0x0
    .long 0x0,0x0,0x0,0x0,0x0,0x0,0x0,0x0
    .long 0x0,0x0,0x0,0x0,0x0,0x0,0x0,0x0
    .long 0x0,0x0,0x0,0x0,0x0,0x0,0x0,0x0
    .long 0x0,0x0,0x0,0x0,0x0,0x0,0x0,0x0
    .long 0x0,0x0,0x3f80,0x0,0x0,0x0,0x3f800000,0x0
    .long 0x0,0x0,0x0,0x3f80,0x0,0x0,0x0,0x3f800000
    .long 0x0,0x0,0x0,0x0,0x0,0x0,0x0,0x0
    .long 0x0,0x0,0x0,0x0,0x0,0x0,0x0,0x0
    .long 0x0,0x0,0x0,0x0,0x0,0x0,0x0,0x0
    .long 0x0,0x0,0x0,0x0,0x0,0x0,0x0,0x0
    .long 0x0,0x0,0x0,0x0,0x0,0x0,0x0,0x0
    .long 0x0,0x0,0x0,0x0,0x0,0x0,0x0,0x0
    .long 0x0,0x0,0x0,0x0,0x0,0x0,0x0,0x0
    .long 0x0,0x0,0x0,0x0,0x0,0x0,0x0,0x0
    .long 0x0,0x0,0x3f80,0x0,0x0,0x0,0x3f800000,0x0
    .long 0x0,0x0,0x0,0x3f80,0x0,0x0,0x0,0x3f800000
    .long 0x3f800000,0x3f800000,0x3f800000,0x3f800000,0x3f800000,0x3f7ffb11,0x3f7fec43,0x3f7fd397
    .long 0x3f800000,0x3f7fec43,0x3f7fb10f,0x3f7f4e6d,0x3f800000,0x3f7fd397,0x3f7f4e6d,0x3f7e70b0
    .long 0x3f800000,0x3f7fb10f,0x3f7ec46d,0x3f7d3aac,0x3f800000,0x3f7f84ab,0x3f7e1324,0x3f7baccd
    .long 0x3f800000,0x3f7f4e6d,0x3f7d3aac,0x3f79c79d,0x3f800000,0x3f7f0e58,0x3f7c3b28,0x3f778bc5
    .long 0x3f800000,0x3f7ec46d,0x3f7b14be,0x3f74fa0b,0x3f800000,0x3f7e70b0,0x3f79c79d,0x3f721352
    .long 0x3f800000,0x3f7e1324,0x3f7853f8,0x3f6ed89e,0x3f800000,0x3f7dabcc,0x3f76ba07,0x3f6b4b0c
    .long 0x3f800000,0x3f7d3aac,0x3f74fa0b,0x3f676bd8,0x3f800000,0x3f7cbfc9,0x3f731447,0x3f633c5a
    .long 0x3f800000,0x3f7c3b28,0x3f710908,0x3f5ebe05,0x3f800000,0x3f7baccd,0x3f6ed89e,0x3f59f26a
    .long 0x3f800000,0x3f800000,0x3f800000,0x3f800000,0x3f7fb10f,0x3f7f84ab,0x3f7f4e6d,0x3f7f0e58
    .long 0x3f7ec46d,0x3f7e1324,0x3f7d3aac,0x3f7c3b28,0x3f7d3aac,0x3f7baccd,0x3f79c79d,0x3f778bc5
    .long 0x3f7b14be,0x3f7853f8,0x3f74fa0b,0x3f710908,0x3f7853f8,0x3f740bdd,0x3f6ed89e,0x3f68bf3c
    .long 0x3f74fa0b,0x3f6ed89e,0x3f676bd8,0x3f5ebe05,0x3f710908,0x3f68bf3c,0x3f5ebe05,0x3f531849
    .long 0x3f6c835e,0x3f61c598,0x3f54db31,0x3f45e403,0x3f676bd8,0x3f59f26a,0x3f49d112,0x3f373a23
    .long 0x3f61c598,0x3f514d3d,0x3f3daef9,0x3f273656,0x3f5b941a,0x3f47de65,0x3f3085bb,0x3f15f6d9
    .long 0x3f54db31,0x3f3daef9,0x3f226799,0x3f039c3d,0x3f4d9f02,0x3f32c8c9,0x3f13682a,0x3ee0924f
    .long 0x3f45e403,0x3f273656,0x3f039c3d,0x3eb8442a,0x3f3daef9,0x3f1b02c6,0x3ee63375,0x3e8e9a22
    .long 0x3f800000,0x3f800000,0x3f800000,0x3f800000,0x3f7ec46d,0x3f7e70b0,0x3f7e1324,0x3f7dabcc
    .long 0x3f7b14be,0x3f79c79d,0x3f7853f8,0x3f76ba07,0x3f74fa0b,0x3f721352,0x3f6ed89e,0x3f6b4b0c
    .long 0x3f6c835e,0x3f676bd8,0x3f61c598,0x3f5b941a,0x3f61c598,0x3f59f26a,0x3f514d3d,0x3f47de65
    .long 0x3f54db31,0x3f49d112,0x3f3daef9,0x3f3085bb,0x3f45e403,0x3f373a23,0x3f273656,0x3f15f6d9
    .long 0x3f3504f3,0x3f226799,0x3f0e39da,0x3ef15aea,0x3f226799,0x3f0b9a6b,0x3ee63375,0x3eb263ef
    .long 0x3f0e39da,0x3ee63375,0x3eac7cd4,0x3e605c13,0x3ef15aea,0x3eb263ef,0x3e605c13,0x3dafb680
    .long 0x3ec3ef15,0x3e78cfcc,0x3dc8bd36,0xbd48fb30,0x3e94a031,0x3e09cf86,0xbcc90ab0,0xbe3b6ecf
    .long 0x3e47c5c2,0x3cc90ab0,0xbe164083,0xbea09ae5,0x3dc8bd36,0xbdafb680,0xbe888e93,0xbee0924f
    .long 0x3f800000,0x3f800000,0x3f800000,0x3f800000,0x3f7d3aac,0x3f7cbfc9,0x3f7c3b28,0x3f7baccd
    .long 0x3f74fa0b,0x3f731447,0x3f710908,0x3f6ed89e,0x3f676bd8,0x3f633c5a,0x3f5ebe05,0x3f59f26a
    .long 0x3f54db31,0x3f4d9f02,0x3f45e403,0x3f3daef9,0x3f3daef9,0x3f32c8c9,0x3f273656,0x3f1b02c6
    .long 0x3f226799,0x3f13682a,0x3f039c3d,0x3ee63375,0x3f039c3d,0x3ee0924f,0x3eb8442a,0x3e8e9a22
    .long 0x3ec3ef15,0x3e94a031,0x3e47c5c2,0x3dc8bd36,0x3e78cfcc,0x3e09cf86,0x3cc90ab0,0xbdafb680
    .long 0x3dc8bd36,0xbcc90ab0,0xbe164083,0xbe888e93,0xbd48fb30,0xbe3b6ecf,0xbea09ae5,0xbee0924f
    .long 0xbe47c5c2,0xbeac7cd4,0xbef15aea,0xbf187fc0,0xbeac7cd4,0xbef6e0cb,0xbf1d7fd1,0xbf3b8f3b
    .long 0xbef15aea,0xbf1d7fd1,0xbf3daef9,0xbf584853,0xbf187fc0,0xbf3b8f3b,0xbf584853,0xbf6db293
    .long 0x0,0x0,0x0,0x0,0x0,0x3c490e90,0x3cc90ab0,0x3d16c32c
    .long 0x0,0x3cc90ab0,0x3d48fb30,0x3d96a905,0x0,0x3d16c32c,0x3d96a905,0x3de1bc2e
    .long 0x0,0x3d48fb30,0x3dc8bd36,0x3e164083,0x0,0x3d7b2b74,0x3dfab273,0x3e3b6ecf
    .long 0x0,0x3d96a905,0x3e164083,0x3e605c13,0x0,0x3dafb680,0x3e2f10a2,0x3e827dc0
    .long 0x0,0x3dc8bd36,0x3e47c5c2,0x3e94a031,0x0,0x3de1bc2e,0x3e605c13,0x3ea68f12
    .long 0x0,0x3dfab273,0x3e78cfcc,0x3eb8442a,0x0,0x3e09cf86,0x3e888e93,0x3ec9b953
    .long 0x0,0x3e164083,0x3e94a031,0x3edae880,0x0,0x3e22abb6,0x3ea09ae5,0x3eebcbbb
    .long 0x0,0x3e2f10a2,0x3eac7cd4,0x3efc5d27,0x0,0x3e3b6ecf,0x3eb8442a,0x3f064b82
    .long 0x0,0x0,0x0,0x0,0x3d48fb30,0x3d7b2b74,0x3d96a905,0x3dafb680
    .long 0x3dc8bd36,0x3dfab273,0x3e164083,0x3e2f10a2,0x3e164083,0x3e3b6ecf,0x3e605c13,0x3e827dc0
    .long 0x3e47c5c2,0x3e78cfcc,0x3e94a031,0x3eac7cd4,0x3e78cfcc,0x3e9aa086,0x3eb8442a,0x3ed53641
    .long 0x3e94a031,0x3eb8442a,0x3edae880,0x3efc5d27,0x3eac7cd4,0x3ed53641,0x3efc5d27,0x3f10d3cd
    .long 0x3ec3ef15,0x3ef15aea,0x3f0e39da,0x3f226799,0x3edae880,0x3f064b82,0x3f1d7fd1,0x3f32c8c9
    .long 0x3ef15aea,0x3f13682a,0x3f2beb4a,0x3f41d870,0x3f039c3d,0x3f1ff6cb,0x3f396842,0x3f4f7a1f
    .long 0x3f0e39da,0x3f2beb4a,0x3f45e403,0x3f5b941a,0x3f187fc0,0x3f373a23,0x3f514d3d,0x3f660f88
    .long 0x3f226799,0x3f41d870,0x3f5b941a,0x3f6ed89e,0x3f2beb4a,0x3f4bbbf8,0x3f64aa59,0x3f75dec6
    .long 0x0,0x0,0x0,0x0,0x3dc8bd36,0x3de1bc2e,0x3dfab273,0x3e09cf86
    .long 0x3e47c5c2,0x3e605c13,0x3e78cfcc,0x3e888e93,0x3e94a031,0x3ea68f12,0x3eb8442a,0x3ec9b953
    .long 0x3ec3ef15,0x3edae880,0x3ef15aea,0x3f039c3d,0x3ef15aea,0x3f064b82,0x3f13682a,0x3f1ff6cb
    .long 0x3f0e39da,0x3f1d7fd1,0x3f2beb4a,0x3f396842,0x3f226799,0x3f32c8c9,0x3f41d870,0x3f4f7a1f
    .long 0x3f3504f3,0x3f45e403,0x3f54db31,0x3f61c598,0x3f45e403,0x3f5695e5,0x3f64aa59,0x3f6ff573
    .long 0x3f54db31,0x3f64aa59,0x3f710908,0x3f79c79d,0x3f61c598,0x3f6ff573,0x3f79c79d,0x3f7f0e58
    .long 0x3f6c835e,0x3f7853f8,0x3f7ec46d,0x3f7fb10f,0x3f74fa0b,0x3f7dabcc,0x3f7fec43,0x3f7baccd
    .long 0x3f7b14be,0x3f7fec43,0x3f7d3aac,0x3f731447,0x3f7ec46d,0x3f7f0e58,0x3f76ba07,0x3f660f88
    .long 0x0,0x0,0x0,0x0,0x3e164083,0x3e22abb6,0x3e2f10a2,0x3e3b6ecf
    .long 0x3e94a031,0x3ea09ae5,0x3eac7cd4,0x3eb8442a,0x3edae880,0x3eebcbbb,0x3efc5d27,0x3f064b82
    .long 0x3f0e39da,0x3f187fc0,0x3f226799,0x3f2beb4a,0x3f2beb4a,0x3f373a23,0x3f41d870,0x3f4bbbf8
    .long 0x3f45e403,0x3f514d3d,0x3f5b941a,0x3f64aa59,0x3f5b941a,0x3f660f88,0x3f6ed89e,0x3f75dec6
    .long 0x3f6c835e,0x3f74fa0b,0x3f7b14be,0x3f7ec46d,0x3f7853f8,0x3f7dabcc,0x3f7fec43,0x3f7f0e58
    .long 0x3f7ec46d,0x3f7fec43,0x3f7d3aac,0x3f76ba07,0x3f7fb10f,0x3f7baccd,0x3f731447,0x3f660f88
    .long 0x3f7b14be,0x3f710908,0x3f61c598,0x3f4d9f02,0x3f710908,0x3f604621,0x3f49d112,0x3f2e3bde
    .long 0x3f61c598,0x3f49d112,0x3f2beb4a,0x3f08f59b,0x3f4d9f02,0x3f2e3bde,0x3f08f59b,0x3ebe1d4a
    .long 0x3f800000,0x3f800000,0x3f800000,0x3f800000,0x3f800000,0x3f7fec43,0x3f7fb10f,0x3f7f4e6d
    .long 0x3f800000,0x3f7fb10f,0x3f7ec46d,0x3f7d3aac,0x3f800000,0x3f7f4e6d,0x3f7d3aac,0x3f79c79d
    .long 0x3f800000,0x3f7ec46d,0x3f7b14be,0x3f74fa0b,0x3f800000,0x3f7e1324,0x3f7853f8,0x3f6ed89e
    .long 0x3f800000,0x3f7d3aac,0x3f74fa0b,0x3f676bd8,0x3f800000,0x3f7c3b28,0x3f710908,0x3f5ebe05
    .long 0x3f800000,0x3f7b14be,0x3f6c835e,0x3f54db31,0x3f800000,0x3f79c79d,0x3f676bd8,0x3f49d112
    .long 0x3f800000,0x3f7853f8,0x3f61c598,0x3f3daef9,0x3f800000,0x3f76ba07,0x3f5b941a,0x3f3085bb
    .long 0x3f800000,0x3f74fa0b,0x3f54db31,0x3f226799,0x3f800000,0x3f731447,0x3f4d9f02,0x3f13682a
    .long 0x3f800000,0x3f710908,0x3f45e403,0x3f039c3d,0x3f800000,0x3f6ed89e,0x3f3daef9,0x3ee63375
    .long 0x3f800000,0x3f800000,0x3f800000,0x3f800000,0x3f7ec46d,0x3f7e1324,0x3f7d3aac,0x3f7c3b28
    .long 0x3f7b14be,0x3f7853f8,0x3f74fa0b,0x3f710908,0x3f74fa0b,0x3f6ed89e,0x3f676bd8,0x3f5ebe05
    .long 0x3f6c835e,0x3f61c598,0x3f54db31,0x3f45e403,0x3f61c598,0x3f514d3d,0x3f3daef9,0x3f273656
    .long 0x3f54db31,0x3f3daef9,0x3f226799,0x3f039c3d,0x3f45e403,0x3f273656,0x3f039c3d,0x3eb8442a
    .long 0x3f3504f3,0x3f0e39da,0x3ec3ef15,0x3e47c5c2,0x3f226799,0x3ee63375,0x3e78cfcc,0x3cc90ab0
    .long 0x3f0e39da,0x3eac7cd4,0x3dc8bd36,0xbe164083,0x3ef15aea,0x3e605c13,0xbd48fb30,0xbea09ae5
    .long 0x3ec3ef15,0x3dc8bd36,0xbe47c5c2,0xbef15aea,0x3e94a031,0xbcc90ab0,0xbeac7cd4,0xbf1d7fd1
    .long 0x3e47c5c2,0xbe164083,0xbef15aea,0xbf3daef9,0x3dc8bd36,0xbe888e93,0xbf187fc0,0xbf584853
    .long 0x3f800000,0x3f800000,0x3f800000,0x3f800000,0x3f7b14be,0x3f79c79d,0x3f7853f8,0x3f76ba07
    .long 0x3f6c835e,0x3f676bd8,0x3f61c598,0x3f5b941a,0x3f54db31,0x3f49d112,0x3f3daef9,0x3f3085bb
    .long 0x3f3504f3,0x3f226799,0x3f0e39da,0x3ef15aea,0x3f0e39da,0x3ee63375,0x3eac7cd4,0x3e605c13
    .long 0x3ec3ef15,0x3e78cfcc,0x3dc8bd36,0xbd48fb30,0x3e47c5c2,0x3cc90ab0,0xbe164083,0xbea09ae5
    .long 0x248d3132,0xbe47c5c2,0xbec3ef15,0xbf0e39da,0xbe47c5c2,0xbecf7bca,0xbf187fc0,0xbf41d870
    .long 0xbec3ef15,0xbf187fc0,0xbf45e403,0xbf676bd8,0xbf0e39da,0xbf41d870,0xbf676bd8,0xbf7c3b28
    .long 0xbf3504f3,0xbf61c598,0xbf7b14be,0xbf7ec46d,0xbf54db31,0xbf76ba07,0xbf7fb10f,0xbf6ed89e
    .long 0xbf6c835e,0xbf7fb10f,0xbf74fa0b,0xbf4d9f02,0xbf7b14be,0xbf7c3b28,0xbf5b941a,0xbf1d7fd1
    .long 0x3f800000,0x3f800000,0x3f800000,0x3f800000,0x3f74fa0b,0x3f731447,0x3f710908,0x3f6ed89e
    .long 0x3f54db31,0x3f4d9f02,0x3f45e403,0x3f3daef9,0x3f226799,0x3f13682a,0x3f039c3d,0x3ee63375
    .long 0x3ec3ef15,0x3e94a031,0x3e47c5c2,0x3dc8bd36,0x3dc8bd36,0xbcc90ab0,0xbe164083,0xbe888e93
    .long 0xbe47c5c2,0xbeac7cd4,0xbef15aea,0xbf187fc0,0xbef15aea,0xbf1d7fd1,0xbf3daef9,0xbf584853
    .long 0xbf3504f3,0xbf54db31,0xbf6c835e,0xbf7b14be,0xbf61c598,0xbf76ba07,0xbf7fb10f,0xbf7c3b28
    .long 0xbf7b14be,0xbf7fb10f,0xbf74fa0b,0xbf5b941a,0xbf7ec46d,0xbf6ed89e,0xbf4d9f02,0xbf1d7fd1
    .long 0xbf6c835e,0xbf45e403,0xbf0e39da,0xbe94a031,0xbf45e403,0xbf08f59b,0xbe78cfcc,0x3d96a905
    .long 0xbf0e39da,0xbe78cfcc,0x3dc8bd36,0x3edae880,0xbe94a031,0x3d96a905,0x3edae880,0x3f396842
    .long 0x0,0x0,0x0,0x0,0x0,0x3cc90ab0,0x3d48fb30,0x3d96a905
    .long 0x0,0x3d48fb30,0x3dc8bd36,0x3e164083,0x0,0x3d96a905,0x3e164083,0x3e605c13
    .long 0x0,0x3dc8bd36,0x3e47c5c2,0x3e94a031,0x0,0x3dfab273,0x3e78cfcc,0x3eb8442a
    .long 0x0,0x3e164083,0x3e94a031,0x3edae880,0x0,0x3e2f10a2,0x3eac7cd4,0x3efc5d27
    .long 0x0,0x3e47c5c2,0x3ec3ef15,0x3f0e39da,0x0,0x3e605c13,0x3edae880,0x3f1d7fd1
    .long 0x0,0x3e78cfcc,0x3ef15aea,0x3f2beb4a,0x0,0x3e888e93,0x3f039c3d,0x3f396842
    .long 0x0,0x3e94a031,0x3f0e39da,0x3f45e403,0x0,0x3ea09ae5,0x3f187fc0,0x3f514d3d
    .long 0x0,0x3eac7cd4,0x3f226799,0x3f5b941a,0x0,0x3eb8442a,0x3f2beb4a,0x3f64aa59
    .long 0x0,0x0,0x0,0x0,0x3dc8bd36,0x3dfab273,0x3e164083,0x3e2f10a2
    .long 0x3e47c5c2,0x3e78cfcc,0x3e94a031,0x3eac7cd4,0x3e94a031,0x3eb8442a,0x3edae880,0x3efc5d27
    .long 0x3ec3ef15,0x3ef15aea,0x3f0e39da,0x3f226799,0x3ef15aea,0x3f13682a,0x3f2beb4a,0x3f41d870
    .long 0x3f0e39da,0x3f2beb4a,0x3f45e403,0x3f5b941a,0x3f226799,0x3f41d870,0x3f5b941a,0x3f6ed89e
    .long 0x3f3504f3,0x3f54db31,0x3f6c835e,0x3f7b14be,0x3f45e403,0x3f64aa59,0x3f7853f8,0x3f7fec43
    .long 0x3f54db31,0x3f710908,0x3f7ec46d,0x3f7d3aac,0x3f61c598,0x3f79c79d,0x3f7fb10f,0x3f731447
    .long 0x3f6c835e,0x3f7ec46d,0x3f7b14be,0x3f61c598,0x3f74fa0b,0x3f7fec43,0x3f710908,0x3f49d112
    .long 0x3f7b14be,0x3f7d3aac,0x3f61c598,0x3f2beb4a,0x3f7ec46d,0x3f76ba07,0x3f4d9f02,0x3f08f59b
    .long 0x0,0x0,0x0,0x0,0x3e47c5c2,0x3e605c13,0x3e78cfcc,0x3e888e93
    .long 0x3ec3ef15,0x3edae880,0x3ef15aea,0x3f039c3d,0x3f0e39da,0x3f1d7fd1,0x3f2beb4a,0x3f396842
    .long 0x3f3504f3,0x3f45e403,0x3f54db31,0x3f61c598,0x3f54db31,0x3f64aa59,0x3f710908,0x3f79c79d
    .long 0x3f6c835e,0x3f7853f8,0x3f7ec46d,0x3f7fb10f,0x3f7b14be,0x3f7fec43,0x3f7d3aac,0x3f731447
    .long 0x3f800000,0x3f7b14be,0x3f6c835e,0x3f54db31,0x3f7b14be,0x3f6a09a7,0x3f4d9f02,0x3f273656
    .long 0x3f6c835e,0x3f4d9f02,0x3f226799,0x3edae880,0x3f54db31,0x3f273656,0x3edae880,0x3e2f10a2
    .long 0x3f3504f3,0x3ef15aea,0x3e47c5c2,0xbdc8bd36,0x3f0e39da,0x3e888e93,0xbd48fb30,0xbeb8442a
    .long 0x3ec3ef15,0x3d48fb30,0xbe94a031,0xbf187fc0,0x3e47c5c2,0xbe2f10a2,0xbf039c3d,0xbf49d112
    .long 0x0,0x0,0x0,0x0,0x3e94a031,0x3ea09ae5,0x3eac7cd4,0x3eb8442a
    .long 0x3f0e39da,0x3f187fc0,0x3f226799,0x3f2beb4a,0x3f45e403,0x3f514d3d,0x3f5b941a,0x3f64aa59
    .long 0x3f6c835e,0x3f74fa0b,0x3f7b14be,0x3f7ec46d,0x3f7ec46d,0x3f7fec43,0x3f7d3aac,0x3f76ba07
    .long 0x3f7b14be,0x3f710908,0x3f61c598,0x3f4d9f02,0x3f61c598,0x3f49d112,0x3f2beb4a,0x3f08f59b
    .long 0x3f3504f3,0x3f0e39da,0x3ec3ef15,0x3e47c5c2,0x3ef15aea,0x3e888e93,0x3d48fb30,0xbe2f10a2
    .long 0x3e47c5c2,0xbd48fb30,0xbe94a031,0xbf039c3d,0xbdc8bd36,0xbeb8442a,0xbf187fc0,0xbf49d112
    .long 0xbec3ef15,0xbf226799,0xbf54db31,0xbf74fa0b,0xbf226799,0xbf584853,0xbf7853f8,0xbf7f4e6d
    .long 0xbf54db31,0xbf7853f8,0xbf7ec46d,0xbf676bd8,0xbf74fa0b,0xbf7f4e6d,0xbf676bd8,0xbf3085bb
.size L_table, 22528
.section .rodata,"a"
.p2align 6
.amdhsa_kernel interleave_layers__ssm_conv_s4d__spectral_gfnet__prompt_kernel
  .amdhsa_next_free_vgpr 256
  .amdhsa_next_free_sgpr 96
  .amdhsa_accum_offset 256
  .amdhsa_group_segment_fixed_size 0
  .amdhsa_kernarg_size 104
  .amdhsa_user_sgpr_count 2
  .amdhsa_user_sgpr_kernarg_segment_ptr 1
  .amdhsa_system_sgpr_workgroup_id_x 1
.end_amdhsa_kernel
```
